```python
import torch

def _softmax(x, axis=-1):
    return torch.softmax(x, dim=axis)

def _gelu(x):
    return torch.nn.functional.gelu(x, approximate='tanh')

def _silu(x):
    return torch.nn.functional.silu(x)

def _sigmoid(x):
    return torch.sigmoid(x)

def _layernorm(x, axis=-1, eps=1e-05):
    m = x.mean(dim=axis, keepdim=True)
    v = x.var(dim=axis, keepdim=True, unbiased=False)
    return (x - m) / torch.sqrt(v + eps)

def _scatter_add(tgt, idx, src, axis=0):
    return tgt.clone().index_add_(axis, idx, src)

def _segment_sum(src, seg, n):
    out = torch.zeros((n,) + src.shape[1:], dtype=src.dtype)
    return out.index_add_(0, seg, src)

def _pad(x, pw):
    flat = tuple((v for pair in reversed(pw) for v in pair))
    return torch.nn.functional.pad(x, flat)
kernel_name = 'adaLN_cond__gqa_block_cached__swiglu_ffn__decode'

def setup_inputs():

    _w = lambda a: (lambda t: t.to(torch.bfloat16) if t.is_floating_point() else t)(torch.as_tensor(a))

    def _A_setup():
        B, Sq, D = (2, 1, 576)
        Hq, Hkv, Sk, Dh = (32, 16, 16384, 128)
        assert Hq % Hkv == 0, (Hq, Hkv)
        return {'x': _w((lambda *s: torch.randn(*s, dtype=torch.bfloat16) * 0.1)(B, Sq, D)), 'k_cache': _w((lambda *s: torch.randn(*s, dtype=torch.bfloat16) * 0.8)(B, Hkv, Sk, Dh)), 'v_cache': _w((lambda *s: torch.randn(*s, dtype=torch.bfloat16) * 0.8)(B, Hkv, Sk, Dh)), 'wq': _w((lambda *s: torch.randn(*s, dtype=torch.bfloat16) * 0.8)(D, Hq * Dh) * D ** (-0.5)), 'wo': _w((lambda *s: torch.randn(*s, dtype=torch.bfloat16) * 0.8)(Hq * Dh, D) * (Hq * Dh) ** (-0.5))}
    _A_in = _A_setup()

    def _B_setup():
        B, S, D, F = (2, 1, 576, 4608)
        return {'x': _w((lambda *s: torch.randn(*s, dtype=torch.bfloat16) * 0.1)(B, S, D)), 'w_gate': _w((lambda *s: torch.randn(*s, dtype=torch.bfloat16) * 0.1)(D, F)), 'w_up': _w((lambda *s: torch.randn(*s, dtype=torch.bfloat16) * 0.1)(D, F)), 'w_down': _w((lambda *s: torch.randn(*s, dtype=torch.bfloat16) * 0.1)(F, D))}
    _B_in = _B_setup()
    return {'A_x': _A_in['x'], 'A_k_cache': _A_in['k_cache'], 'A_v_cache': _A_in['v_cache'], 'A_wq': _A_in['wq'], 'A_wo': _A_in['wo'], 'B_x': _B_in['x'], 'B_w_gate': _B_in['w_gate'], 'B_w_up': _B_in['w_up'], 'B_w_down': _B_in['w_down'], 'c': _w((lambda *s: torch.randn(*s, dtype=torch.bfloat16) * 0.4)(2, 576) * 8.0), 'w_mod': _w((lambda *s: torch.randn(*s, dtype=torch.bfloat16) * 0.4)(576, 6 * 576) * 576 ** (-0.5) * 8.0)}

def reference(A_x, A_k_cache, A_v_cache, A_wq, A_wo, B_x, B_w_gate, B_w_up, B_w_down, c, w_mod):

    def _A_ref(x, k_cache, v_cache, wq, wo):
        B, Sq, D = x.shape
        Hq, Dh = (32, 128)
        Hkv = k_cache.shape[1]
        rep = Hq // Hkv
        q = (lambda x, *d: x.permute(*d))((x @ wq).reshape(B, Sq, Hq, Dh), 0, 2, 1, 3)
        k = (lambda x, n, axis: torch.repeat_interleave(x, n, dim=axis))(k_cache, rep, axis=1)
        v = (lambda x, n, axis: torch.repeat_interleave(x, n, dim=axis))(v_cache, rep, axis=1)
        scores = torch.einsum('bhqd,bhkd->bhqk', q, k) * Dh ** (-0.5)
        p = _softmax(scores, axis=-1)
        o = torch.einsum('bhqk,bhkd->bhqd', p, v)
        return (lambda x, *d: x.permute(*d))(o, 0, 2, 1, 3).reshape(B, Sq, Hq * Dh) @ wo

    def _B_ref(x, w_gate, w_up, w_down):
        g = _silu(x @ w_gate)
        u = x @ w_up
        return g * u @ w_down
    x = A_x
    mod = (_silu(c) @ w_mod).reshape(c.shape[0], 6, 1, -1)
    sa, ca, ga, sb, cb, gb = (mod[:, 0].clone(), mod[:, 1].clone(), mod[:, 2].clone(), mod[:, 3].clone(), mod[:, 4].clone(), mod[:, 5].clone())
    h = _layernorm(x, axis=-1) * (1 + ca) + sa
    x = x + ga * _A_ref(h, A_k_cache, A_v_cache, A_wq, A_wo)
    h = _layernorm(x, axis=-1) * (1 + cb) + sb
    x = x + gb * _B_ref(h, B_w_gate, B_w_up, B_w_down)
    return x
```

```asm
; @launch grid=(256,1,1) block=(512,1,1) lds=163840
.amdgcn_target "amdgcn-amd-amdhsa--gfx950"
.text
.globl adaLN_cond__gqa_block_cached__swiglu_ffn__decode_kernel
.p2align 8
.type adaLN_cond__gqa_block_cached__swiglu_ffn__decode_kernel,@function
adaLN_cond__gqa_block_cached__swiglu_ffn__decode_kernel:
    s_cmp_ge_u32 s2, 256
    s_cbranch_scc1 L_end
    s_load_dwordx16 s[16:31], s[0:1], 0
    s_load_dwordx8 s[32:39], s[0:1], 64
    s_load_dwordx4 s[40:43], s[0:1], 96
    v_lshrrev_b32 v1, 6, v0
    s_nop 0
    v_readfirstlane_b32 s3, v1
    v_and_b32 v1, 63, v0
    s_lshr_b32 s5, s2, 4
    s_add_u32 s4, s2, s5
    s_and_b32 s4, s4, 15
    s_sub_u32 s64, s2, 144
    s_cmp_lt_u32 s2, 144
    s_cselect_b32 s6, 1, 0
    s_cselect_b32 s64, s2, s64
    s_and_b32 s65, s64, 0xfffffff0
    s_and_b32 s66, s64, 7
    s_lshl_b32 s66, s66, 1
    s_or_b32 s65, s65, s66
    s_lshr_b32 s66, s64, 3
    s_and_b32 s66, s66, 1
    s_or_b32 s7, s65, s66
    s_sub_u32 s65, s7, 48
    s_cmp_ge_u32 s7, 48
    s_cselect_b32 s8, s65, -1
    s_cselect_b32 s9, -1, s7
    s_cmp_lt_u32 s7, 36
    s_cselect_b32 s66, s7, -1
    s_cmp_ge_u32 s7, 96
    s_cselect_b32 s67, 1, 0
    s_sub_u32 s65, s7, 18
    s_cmp_lt_u32 s65, 6
    s_cselect_b32 s65, 1, 0
    s_cmp_eq_u32 s6, 1
    s_cselect_b32 s8, -1, s8
    s_cselect_b32 s9, -1, s9
    s_cselect_b32 s11, -1, s66
    s_cselect_b32 s10, 0, s67
    s_cselect_b32 s61, 0, s65
    s_waitcnt lgkmcnt(0)
    s_cmp_ge_u32 s3, 4
    s_cbranch_scc1 L_ctrl
    s_mov_b32 s44, s18
    s_mov_b32 s45, s19
    s_mov_b32 s46, 134217728
    s_mov_b32 s47, 0x20000
    v_and_b32 v6, 7, v1
    v_lshlrev_b32 v6, 8, v6
    v_lshrrev_b32 v7, 3, v1
    v_lshlrev_b32 v7, 4, v7
    v_add_u32 v96, v6, v7
    v_add_u32 v97, 128, v96
    v_add_u32 v98, 2048, v96
    v_add_u32 v99, 2176, v96
    v_add_u32 v100, 4096, v96
    v_add_u32 v101, 4224, v96
    v_add_u32 v102, 6144, v96
    v_add_u32 v103, 6272, v96
    v_lshlrev_b32 v4, 4, v1
    s_lshl_b32 s80, s4, 22
    s_lshl_b32 s64, s5, 18
    s_add_u32 s80, s80, s64
    s_lshl_b32 s64, s3, 13
    s_add_u32 s80, s80, s64
    s_mov_b32 s81, s80
    s_cmp_eq_u32 s6, 1
    s_cbranch_scc0 L_st_hold
    buffer_load_dwordx4 v[128:131], v96, s[44:47], s81 offen nt
    buffer_load_dwordx4 v[132:135], v97, s[44:47], s81 offen nt
    buffer_load_dwordx4 v[136:139], v98, s[44:47], s81 offen nt
    buffer_load_dwordx4 v[140:143], v99, s[44:47], s81 offen nt
    buffer_load_dwordx4 v[144:147], v100, s[44:47], s81 offen nt
    buffer_load_dwordx4 v[148:151], v101, s[44:47], s81 offen nt
    buffer_load_dwordx4 v[152:155], v102, s[44:47], s81 offen nt
    buffer_load_dwordx4 v[156:159], v103, s[44:47], s81 offen nt
    s_add_u32 s81, s81, 32768
    s_barrier
    s_branch L_st_go
L_st_hold:
    s_barrier
    v_mov_b32 v13, 147456
    s_mov_b32 s68, 524288
L_spin_1:
    ds_read_b32 v15, v13 offset:40
    s_waitcnt lgkmcnt(0)
    v_readfirstlane_b32 s69, v15
    s_nop 0
    s_cmp_ge_u32 s69, 128
    s_cbranch_scc1 L_spind_2
    s_sub_u32 s68, s68, 1
    s_cbranch_scc1 L_abort
    s_sleep 1
    s_branch L_spin_1
L_spind_2:
    buffer_load_dwordx4 v[128:131], v96, s[44:47], s81 offen nt
    buffer_load_dwordx4 v[132:135], v97, s[44:47], s81 offen nt
    buffer_load_dwordx4 v[136:139], v98, s[44:47], s81 offen nt
    buffer_load_dwordx4 v[140:143], v99, s[44:47], s81 offen nt
    buffer_load_dwordx4 v[144:147], v100, s[44:47], s81 offen nt
    buffer_load_dwordx4 v[148:151], v101, s[44:47], s81 offen nt
    buffer_load_dwordx4 v[152:155], v102, s[44:47], s81 offen nt
    buffer_load_dwordx4 v[156:159], v103, s[44:47], s81 offen nt
    s_add_u32 s81, s81, 32768
L_st_go:
    v_lshrrev_b32 v6, 2, v1
    v_mul_u32_u24 v8, 9216, v6
    v_and_b32 v6, 3, v1
    v_lshlrev_b32 v6, 4, v6
    v_add_u32 v8, v8, v6
    s_cmp_eq_u32 s6, 0
    s_cbranch_scc1 L_st_nonffn
    s_mov_b32 s52, s28
    s_mov_b32 s53, s29
    s_mov_b32 s54, 5308416
    s_mov_b32 s55, 0x20000
    s_mul_i32 s64, s3, 1327104
    s_lshl_b32 s67, s7, 6
    s_add_u32 s64, s64, s67
    s_mul_i32 s65, s3, 9216
    s_add_u32 s65, s65, 0
    s_mov_b32 s66, 9
L_dma_3:
    s_mov_b32 m0, s65
    s_waitcnt vmcnt(5)
    buffer_load_dwordx4 v8, s[52:55], s64 offen nt lds
    s_add_u32 s64, s64, 147456
    s_add_u32 s65, s65, 1024
    s_sub_u32 s66, s66, 1
    s_cmp_lg_u32 s66, 0
    s_cbranch_scc1 L_dma_3
    s_mov_b32 s52, s30
    s_mov_b32 s53, s31
    s_mov_b32 s54, 5308416
    s_mov_b32 s55, 0x20000
    s_mul_i32 s64, s3, 1327104
    s_lshl_b32 s67, s7, 6
    s_add_u32 s64, s64, s67
    s_mul_i32 s65, s3, 9216
    s_add_u32 s65, s65, 36864
    s_mov_b32 s66, 9
L_dma_4:
    s_mov_b32 m0, s65
    s_waitcnt vmcnt(5)
    buffer_load_dwordx4 v8, s[52:55], s64 offen nt lds
    s_add_u32 s64, s64, 147456
    s_add_u32 s65, s65, 1024
    s_sub_u32 s66, s66, 1
    s_cmp_lg_u32 s66, 0
    s_cbranch_scc1 L_dma_4
    s_mov_b32 s52, s32
    s_mov_b32 s53, s33
    s_mov_b32 s54, 5308416
    s_mov_b32 s55, 0x20000
    s_add_u32 s67, s7, 0
    s_mul_i32 s64, s67, 36864
    s_mul_i32 s67, s3, 9216
    s_add_u32 s64, s64, s67
    s_mul_i32 s65, s3, 9216
    s_add_u32 s65, s65, 73728
    s_mov_b32 s66, 9
L_dma_5:
    s_mov_b32 m0, s65
    s_waitcnt vmcnt(5)
    buffer_load_dwordx4 v4, s[52:55], s64 offen nt lds
    s_add_u32 s64, s64, 1024
    s_add_u32 s65, s65, 1024
    s_sub_u32 s66, s66, 1
    s_cmp_lg_u32 s66, 0
    s_cbranch_scc1 L_dma_5
    s_branch L_st_fill
L_st_nonffn:
    s_mov_b32 s52, s24
    s_mov_b32 s53, s25
    s_mov_b32 s54, 4718592
    s_mov_b32 s55, 0x20000
    s_add_u32 s67, s7, 0
    s_mul_i32 s64, s67, 36864
    s_mul_i32 s67, s3, 9216
    s_add_u32 s64, s64, s67
    s_mul_i32 s65, s3, 9216
    s_add_u32 s65, s65, 0
    s_mov_b32 s66, 9
L_dma_6:
    s_mov_b32 m0, s65
    s_waitcnt vmcnt(5)
    buffer_load_dwordx4 v4, s[52:55], s64 offen nt lds
    s_add_u32 s64, s64, 1024
    s_add_u32 s65, s65, 1024
    s_sub_u32 s66, s66, 1
    s_cmp_lg_u32 s66, 0
    s_cbranch_scc1 L_dma_6
    s_cmp_eq_u32 s10, 0
    s_cbranch_scc1 L_st_fill
    s_mov_b32 s52, s24
    s_mov_b32 s53, s25
    s_mov_b32 s54, 4718592
    s_mov_b32 s55, 0x20000
    s_add_u32 s67, s7, 16
    s_mul_i32 s64, s67, 36864
    s_mul_i32 s67, s3, 9216
    s_add_u32 s64, s64, s67
    s_mul_i32 s65, s3, 9216
    s_add_u32 s65, s65, 36864
    s_mov_b32 s66, 9
L_dma_7:
    s_mov_b32 m0, s65
    s_waitcnt vmcnt(5)
    buffer_load_dwordx4 v4, s[52:55], s64 offen nt lds
    s_add_u32 s64, s64, 1024
    s_add_u32 s65, s65, 1024
    s_sub_u32 s66, s66, 1
    s_cmp_lg_u32 s66, 0
    s_cbranch_scc1 L_dma_7
L_st_fill:
    v_mov_b32 v13, 147456
    v_mov_b32 v14, 1
    s_waitcnt vmcnt(5)
    buffer_load_dwordx4 v[160:163], v96, s[44:47], s81 offen nt
    s_waitcnt vmcnt(5)
    buffer_load_dwordx4 v[164:167], v97, s[44:47], s81 offen nt
    s_waitcnt vmcnt(5)
    buffer_load_dwordx4 v[168:171], v98, s[44:47], s81 offen nt
    s_waitcnt vmcnt(5)
    buffer_load_dwordx4 v[172:175], v99, s[44:47], s81 offen nt
    s_waitcnt vmcnt(5)
    buffer_load_dwordx4 v[176:179], v100, s[44:47], s81 offen nt
    s_waitcnt vmcnt(5)
    buffer_load_dwordx4 v[180:183], v101, s[44:47], s81 offen nt
    s_waitcnt vmcnt(5)
    buffer_load_dwordx4 v[184:187], v102, s[44:47], s81 offen nt
    s_waitcnt vmcnt(5)
    buffer_load_dwordx4 v[188:191], v103, s[44:47], s81 offen nt
    s_add_u32 s81, s81, 32768
    ds_add_u32 v13, v14 offset:48
    s_waitcnt vmcnt(5)
    buffer_load_dwordx4 v[192:195], v96, s[44:47], s81 offen nt
    s_waitcnt vmcnt(5)
    buffer_load_dwordx4 v[196:199], v97, s[44:47], s81 offen nt
    s_waitcnt vmcnt(5)
    buffer_load_dwordx4 v[200:203], v98, s[44:47], s81 offen nt
    s_waitcnt vmcnt(5)
    buffer_load_dwordx4 v[204:207], v99, s[44:47], s81 offen nt
    s_waitcnt vmcnt(5)
    buffer_load_dwordx4 v[208:211], v100, s[44:47], s81 offen nt
    s_waitcnt vmcnt(5)
    buffer_load_dwordx4 v[212:215], v101, s[44:47], s81 offen nt
    s_waitcnt vmcnt(5)
    buffer_load_dwordx4 v[216:219], v102, s[44:47], s81 offen nt
    s_waitcnt vmcnt(5)
    buffer_load_dwordx4 v[220:223], v103, s[44:47], s81 offen nt
    s_add_u32 s81, s81, 32768
    s_waitcnt vmcnt(5)
    buffer_load_dwordx4 v[224:227], v96, s[44:47], s81 offen nt
    s_waitcnt vmcnt(5)
    buffer_load_dwordx4 v[228:231], v97, s[44:47], s81 offen nt
    s_waitcnt vmcnt(5)
    buffer_load_dwordx4 v[232:235], v98, s[44:47], s81 offen nt
    s_waitcnt vmcnt(5)
    buffer_load_dwordx4 v[236:239], v99, s[44:47], s81 offen nt
    s_waitcnt vmcnt(5)
    buffer_load_dwordx4 v[240:243], v100, s[44:47], s81 offen nt
    s_waitcnt vmcnt(5)
    buffer_load_dwordx4 v[244:247], v101, s[44:47], s81 offen nt
    s_waitcnt vmcnt(5)
    buffer_load_dwordx4 v[248:251], v102, s[44:47], s81 offen nt
    s_waitcnt vmcnt(5)
    buffer_load_dwordx4 v[252:255], v103, s[44:47], s81 offen nt
    s_add_u32 s81, s81, 32768
    s_waitcnt vmcnt(5)
    buffer_load_dwordx4 v[72:75], v96, s[44:47], s81 offen nt
    s_waitcnt vmcnt(5)
    buffer_load_dwordx4 v[76:79], v97, s[44:47], s81 offen nt
    s_waitcnt vmcnt(5)
    buffer_load_dwordx4 v[80:83], v98, s[44:47], s81 offen nt
    s_waitcnt vmcnt(5)
    buffer_load_dwordx4 v[84:87], v99, s[44:47], s81 offen nt
    s_waitcnt vmcnt(5)
    buffer_load_dwordx4 v[88:91], v100, s[44:47], s81 offen nt
    s_waitcnt vmcnt(5)
    buffer_load_dwordx4 v[92:95], v101, s[44:47], s81 offen nt
    s_waitcnt vmcnt(5)
    buffer_load_dwordx4 v[104:107], v102, s[44:47], s81 offen nt
    s_waitcnt vmcnt(5)
    buffer_load_dwordx4 v[108:111], v103, s[44:47], s81 offen nt
    v_and_b32 v6, 15, v1
    v_lshrrev_b32 v7, 4, v1
    v_lshrrev_b32 v16, 2, v6
    v_cmp_eq_u32 s[70:71], 0, v16
    v_cmp_eq_u32 s[72:73], 1, v16
    v_cmp_eq_u32 s[74:75], 2, v16
    v_cmp_eq_u32 s[76:77], 3, v16
    v_and_b32 v16, 1, v6
    v_lshlrev_b32 v16, 8, v16
    v_lshlrev_b32 v17, 1, v7
    v_bfe_u32 v18, v6, 1, 1
    v_add_u32 v17, v17, v18
    v_lshlrev_b32 v17, 4, v17
    v_add_u32 v16, v16, v17
    v_add_u32 v9, 152320, v16
    v_bfe_u32 v16, v1, 3, 1
    v_lshlrev_b32 v16, 12, v16
    v_and_b32 v17, 3, v1
    v_lshlrev_b32 v17, 5, v17
    v_add_u32 v16, v16, v17
    v_bfe_u32 v17, v1, 2, 1
    v_lshlrev_b32 v18, 1, v7
    v_add_u32 v17, v17, v18
    v_lshlrev_b32 v17, 2, v17
    v_add_u32 v16, v16, v17
    s_lshl_b32 s64, s3, 7
    s_add_u32 s65, s64, 110592
    v_add_u32 v10, s65, v16
    v_and_b32 v16, 1, v6
    v_lshlrev_b32 v16, 6, v16
    v_lshlrev_b32 v17, 4, v7
    v_add_u32 v16, v16, v17
    s_add_u32 s65, s64, 126976
    v_add_u32 v11, s65, v16
    v_lshlrev_b32 v16, 5, v6
    s_lshl_b32 s64, s3, 10
    s_add_u32 s64, s64, 135168
    v_add_u32 v12, s64, v16
    v_mov_b32 v13, 147456
    v_mov_b32 v5, 147456
    v_mov_b32 v14, 1
    s_mov_b32 s78, 0x05040100
    s_mov_b32 s79, 0x07060302
    s_mov_b32 s68, 524288
L_spin_8:
    ds_read_b32 v15, v13 offset:4
    s_waitcnt lgkmcnt(0)
    v_readfirstlane_b32 s69, v15
    s_nop 0
    s_cmp_ge_u32 s69, 64
    s_cbranch_scc1 L_spind_9
    s_sub_u32 s68, s68, 1
    s_cbranch_scc1 L_abort
    s_sleep 1
    s_branch L_spin_8
L_spind_9:
    s_mov_b32 s82, 0
L_kloop:
    s_and_b32 s64, s82, 1
    s_cmp_eq_u32 s64, 0
    s_cbranch_scc0 L_k_noq
    ds_read_b128 v[64:67], v9
    ds_read_b128 v[68:71], v9 offset:128
    v_add_u32 v9, 512, v9
    s_waitcnt lgkmcnt(0)
    v_cndmask_b32 v16, 0, v64, s[70:71]
    v_cndmask_b32 v17, 0, v65, s[70:71]
    v_cndmask_b32 v18, 0, v66, s[70:71]
    v_cndmask_b32 v19, 0, v67, s[70:71]
    v_cndmask_b32 v20, 0, v68, s[70:71]
    v_cndmask_b32 v21, 0, v69, s[70:71]
    v_cndmask_b32 v22, 0, v70, s[70:71]
    v_cndmask_b32 v23, 0, v71, s[70:71]
    v_cndmask_b32 v24, 0, v64, s[72:73]
    v_cndmask_b32 v25, 0, v65, s[72:73]
    v_cndmask_b32 v26, 0, v66, s[72:73]
    v_cndmask_b32 v27, 0, v67, s[72:73]
    v_cndmask_b32 v28, 0, v68, s[72:73]
    v_cndmask_b32 v29, 0, v69, s[72:73]
    v_cndmask_b32 v30, 0, v70, s[72:73]
    v_cndmask_b32 v31, 0, v71, s[72:73]
    v_cndmask_b32 v32, 0, v64, s[74:75]
    v_cndmask_b32 v33, 0, v65, s[74:75]
    v_cndmask_b32 v34, 0, v66, s[74:75]
    v_cndmask_b32 v35, 0, v67, s[74:75]
    v_cndmask_b32 v36, 0, v68, s[74:75]
    v_cndmask_b32 v37, 0, v69, s[74:75]
    v_cndmask_b32 v38, 0, v70, s[74:75]
    v_cndmask_b32 v39, 0, v71, s[74:75]
    v_cndmask_b32 v40, 0, v64, s[76:77]
    v_cndmask_b32 v41, 0, v65, s[76:77]
    v_cndmask_b32 v42, 0, v66, s[76:77]
    v_cndmask_b32 v43, 0, v67, s[76:77]
    v_cndmask_b32 v44, 0, v68, s[76:77]
    v_cndmask_b32 v45, 0, v69, s[76:77]
    v_cndmask_b32 v46, 0, v70, s[76:77]
    v_cndmask_b32 v47, 0, v71, s[76:77]
L_k_noq:
    s_add_u32 s66, s82, 1
    s_bfe_u32 s64, s66, 0x10001
    s_lshl_b32 s64, s64, 26
    s_and_b32 s65, s66, 1
    s_lshl_b32 s65, s65, 17
    s_add_u32 s81, s80, s64
    s_add_u32 s81, s81, s65
    s_cmp_eq_u32 s82, 3
    s_cbranch_scc0 L_k_nosw
    s_mov_b32 s44, s20
    s_mov_b32 s45, s21
    v_add_u32 v96, 0, v4
    v_add_u32 v97, 1024, v4
    v_add_u32 v98, 2048, v4
    v_add_u32 v99, 3072, v4
    v_add_u32 v100, 4096, v4
    v_add_u32 v101, 5120, v4
    v_add_u32 v102, 6144, v4
    v_add_u32 v103, 7168, v4
L_k_nosw:
    v_mfma_f32_16x16x32_bf16 v[48:51], v[16:19], v[128:131], 0
    v_mfma_f32_16x16x32_bf16 v[48:51], v[20:23], v[132:135], v[48:51]
    v_mfma_f32_16x16x32_bf16 v[48:51], v[24:27], v[136:139], v[48:51]
    v_mfma_f32_16x16x32_bf16 v[48:51], v[28:31], v[140:143], v[48:51]
    v_mfma_f32_16x16x32_bf16 v[48:51], v[32:35], v[144:147], v[48:51]
    v_mfma_f32_16x16x32_bf16 v[48:51], v[36:39], v[148:151], v[48:51]
    v_mfma_f32_16x16x32_bf16 v[48:51], v[40:43], v[152:155], v[48:51]
    v_mfma_f32_16x16x32_bf16 v[48:51], v[44:47], v[156:159], v[48:51]
    s_nop 7
    v_add_f32_dpp v52, v50, v48 row_ror:8 row_mask:0xf bank_mask:0x3
    s_nop 1
    v_add_f32_dpp v52, v49, v51 row_ror:8 row_mask:0xf bank_mask:0xc
    ds_write_b32 v10, v52 offset:0
    s_cmp_eq_u32 s82, 0
    s_cbranch_scc0 L_k_x_10
    s_waitcnt vmcnt(0)
    v_mov_b32 v128, v72
    v_mov_b32 v129, v73
    v_mov_b32 v130, v74
    v_mov_b32 v131, v75
    v_mov_b32 v132, v76
    v_mov_b32 v133, v77
    v_mov_b32 v134, v78
    v_mov_b32 v135, v79
    v_mov_b32 v136, v80
    v_mov_b32 v137, v81
    v_mov_b32 v138, v82
    v_mov_b32 v139, v83
    v_mov_b32 v140, v84
    v_mov_b32 v141, v85
    v_mov_b32 v142, v86
    v_mov_b32 v143, v87
    v_mov_b32 v144, v88
    v_mov_b32 v145, v89
    v_mov_b32 v146, v90
    v_mov_b32 v147, v91
    v_mov_b32 v148, v92
    v_mov_b32 v149, v93
    v_mov_b32 v150, v94
    v_mov_b32 v151, v95
    v_mov_b32 v152, v104
    v_mov_b32 v153, v105
    v_mov_b32 v154, v106
    v_mov_b32 v155, v107
    v_mov_b32 v156, v108
    v_mov_b32 v157, v109
    v_mov_b32 v158, v110
    v_mov_b32 v159, v111
    s_add_u32 s81, s81, 32768
    s_branch L_k_y_11
L_k_x_10:
    s_waitcnt vmcnt(7)
    buffer_load_dwordx4 v[128:131], v96, s[44:47], s81 offen nt
    s_waitcnt vmcnt(7)
    buffer_load_dwordx4 v[132:135], v97, s[44:47], s81 offen nt
    s_waitcnt vmcnt(7)
    buffer_load_dwordx4 v[136:139], v98, s[44:47], s81 offen nt
    s_waitcnt vmcnt(7)
    buffer_load_dwordx4 v[140:143], v99, s[44:47], s81 offen nt
    s_waitcnt vmcnt(7)
    buffer_load_dwordx4 v[144:147], v100, s[44:47], s81 offen nt
    s_waitcnt vmcnt(7)
    buffer_load_dwordx4 v[148:151], v101, s[44:47], s81 offen nt
    s_waitcnt vmcnt(7)
    buffer_load_dwordx4 v[152:155], v102, s[44:47], s81 offen nt
    s_waitcnt vmcnt(7)
    buffer_load_dwordx4 v[156:159], v103, s[44:47], s81 offen nt
    s_add_u32 s81, s81, 32768
L_k_y_11:
    v_mfma_f32_16x16x32_bf16 v[48:51], v[16:19], v[160:163], 0
    v_mfma_f32_16x16x32_bf16 v[48:51], v[20:23], v[164:167], v[48:51]
    v_mfma_f32_16x16x32_bf16 v[48:51], v[24:27], v[168:171], v[48:51]
    v_mfma_f32_16x16x32_bf16 v[48:51], v[28:31], v[172:175], v[48:51]
    v_mfma_f32_16x16x32_bf16 v[48:51], v[32:35], v[176:179], v[48:51]
    v_mfma_f32_16x16x32_bf16 v[48:51], v[36:39], v[180:183], v[48:51]
    v_mfma_f32_16x16x32_bf16 v[48:51], v[40:43], v[184:187], v[48:51]
    v_mfma_f32_16x16x32_bf16 v[48:51], v[44:47], v[188:191], v[48:51]
    s_nop 7
    v_add_f32_dpp v52, v50, v48 row_ror:8 row_mask:0xf bank_mask:0x3
    s_nop 1
    v_add_f32_dpp v52, v49, v51 row_ror:8 row_mask:0xf bank_mask:0xc
    ds_write_b32 v10, v52 offset:512
    s_waitcnt vmcnt(7)
    buffer_load_dwordx4 v[160:163], v96, s[44:47], s81 offen nt
    s_waitcnt vmcnt(7)
    buffer_load_dwordx4 v[164:167], v97, s[44:47], s81 offen nt
    s_waitcnt vmcnt(7)
    buffer_load_dwordx4 v[168:171], v98, s[44:47], s81 offen nt
    s_waitcnt vmcnt(7)
    buffer_load_dwordx4 v[172:175], v99, s[44:47], s81 offen nt
    s_waitcnt vmcnt(7)
    buffer_load_dwordx4 v[176:179], v100, s[44:47], s81 offen nt
    s_waitcnt vmcnt(7)
    buffer_load_dwordx4 v[180:183], v101, s[44:47], s81 offen nt
    s_waitcnt vmcnt(7)
    buffer_load_dwordx4 v[184:187], v102, s[44:47], s81 offen nt
    s_waitcnt vmcnt(7)
    buffer_load_dwordx4 v[188:191], v103, s[44:47], s81 offen nt
    s_add_u32 s81, s81, 32768
    v_mfma_f32_16x16x32_bf16 v[48:51], v[16:19], v[192:195], 0
    v_mfma_f32_16x16x32_bf16 v[48:51], v[20:23], v[196:199], v[48:51]
    v_mfma_f32_16x16x32_bf16 v[48:51], v[24:27], v[200:203], v[48:51]
    v_mfma_f32_16x16x32_bf16 v[48:51], v[28:31], v[204:207], v[48:51]
    v_mfma_f32_16x16x32_bf16 v[48:51], v[32:35], v[208:211], v[48:51]
    v_mfma_f32_16x16x32_bf16 v[48:51], v[36:39], v[212:215], v[48:51]
    v_mfma_f32_16x16x32_bf16 v[48:51], v[40:43], v[216:219], v[48:51]
    v_mfma_f32_16x16x32_bf16 v[48:51], v[44:47], v[220:223], v[48:51]
    s_nop 7
    v_add_f32_dpp v52, v50, v48 row_ror:8 row_mask:0xf bank_mask:0x3
    s_nop 1
    v_add_f32_dpp v52, v49, v51 row_ror:8 row_mask:0xf bank_mask:0xc
    ds_write_b32 v10, v52 offset:1024
    s_waitcnt vmcnt(7)
    buffer_load_dwordx4 v[192:195], v96, s[44:47], s81 offen nt
    s_waitcnt vmcnt(7)
    buffer_load_dwordx4 v[196:199], v97, s[44:47], s81 offen nt
    s_waitcnt vmcnt(7)
    buffer_load_dwordx4 v[200:203], v98, s[44:47], s81 offen nt
    s_waitcnt vmcnt(7)
    buffer_load_dwordx4 v[204:207], v99, s[44:47], s81 offen nt
    s_waitcnt vmcnt(7)
    buffer_load_dwordx4 v[208:211], v100, s[44:47], s81 offen nt
    s_waitcnt vmcnt(7)
    buffer_load_dwordx4 v[212:215], v101, s[44:47], s81 offen nt
    s_waitcnt vmcnt(7)
    buffer_load_dwordx4 v[216:219], v102, s[44:47], s81 offen nt
    s_waitcnt vmcnt(7)
    buffer_load_dwordx4 v[220:223], v103, s[44:47], s81 offen nt
    s_add_u32 s81, s81, 32768
    v_mfma_f32_16x16x32_bf16 v[48:51], v[16:19], v[224:227], 0
    v_mfma_f32_16x16x32_bf16 v[48:51], v[20:23], v[228:231], v[48:51]
    v_mfma_f32_16x16x32_bf16 v[48:51], v[24:27], v[232:235], v[48:51]
    v_mfma_f32_16x16x32_bf16 v[48:51], v[28:31], v[236:239], v[48:51]
    v_mfma_f32_16x16x32_bf16 v[48:51], v[32:35], v[240:243], v[48:51]
    v_mfma_f32_16x16x32_bf16 v[48:51], v[36:39], v[244:247], v[48:51]
    v_mfma_f32_16x16x32_bf16 v[48:51], v[40:43], v[248:251], v[48:51]
    v_mfma_f32_16x16x32_bf16 v[48:51], v[44:47], v[252:255], v[48:51]
    s_nop 7
    v_add_f32_dpp v52, v50, v48 row_ror:8 row_mask:0xf bank_mask:0x3
    s_nop 1
    v_add_f32_dpp v52, v49, v51 row_ror:8 row_mask:0xf bank_mask:0xc
    ds_write_b32 v10, v52 offset:1536
    s_and_b32 s64, s82, 1
    s_cmp_eq_u32 s64, 0
    s_cbranch_scc1 L_k_nosig
    ds_add_u32 v5, v14 offset:8
    v_add_u32 v5, 4, v5
    v_add_u32 v10, 4096, v10
L_k_nosig:
    v_add_u32 v10, 2048, v10
    s_waitcnt vmcnt(7)
    buffer_load_dwordx4 v[224:227], v96, s[44:47], s81 offen nt
    s_waitcnt vmcnt(7)
    buffer_load_dwordx4 v[228:231], v97, s[44:47], s81 offen nt
    s_waitcnt vmcnt(7)
    buffer_load_dwordx4 v[232:235], v98, s[44:47], s81 offen nt
    s_waitcnt vmcnt(7)
    buffer_load_dwordx4 v[236:239], v99, s[44:47], s81 offen nt
    s_waitcnt vmcnt(7)
    buffer_load_dwordx4 v[240:243], v100, s[44:47], s81 offen nt
    s_waitcnt vmcnt(7)
    buffer_load_dwordx4 v[244:247], v101, s[44:47], s81 offen nt
    s_waitcnt vmcnt(7)
    buffer_load_dwordx4 v[248:251], v102, s[44:47], s81 offen nt
    s_waitcnt vmcnt(7)
    buffer_load_dwordx4 v[252:255], v103, s[44:47], s81 offen nt
    s_add_u32 s81, s81, 32768
    ds_add_u32 v13, v14 offset:44
    s_add_u32 s82, s82, 1
    s_cmp_lt_u32 s82, 4
    s_cbranch_scc1 L_kloop
    s_mov_b32 s82, 0
    v_mov_b32 v5, 147456
L_vloop:
    s_and_b32 s64, s82, 1
    s_cmp_eq_u32 s64, 0
    s_cbranch_scc0 L_v_nop
    s_mov_b32 s68, 524288
L_spin_12:
    ds_read_b32 v15, v5 offset:16
    s_waitcnt lgkmcnt(0)
    v_readfirstlane_b32 s69, v15
    s_nop 0
    s_cmp_ge_u32 s69, 256
    s_cbranch_scc1 L_spind_13
    s_sub_u32 s68, s68, 1
    s_cbranch_scc1 L_abort
    s_sleep 1
    s_branch L_spin_12
L_spind_13:
    v_mov_b32 v16, 0
    v_mov_b32 v17, 0
    v_mov_b32 v18, 0
    v_mov_b32 v19, 0
    v_mov_b32 v20, 0
    v_mov_b32 v21, 0
    v_mov_b32 v22, 0
    v_mov_b32 v23, 0
    v_mov_b32 v24, 0
    v_mov_b32 v25, 0
    v_mov_b32 v26, 0
    v_mov_b32 v27, 0
    v_mov_b32 v28, 0
    v_mov_b32 v29, 0
    v_mov_b32 v30, 0
    v_mov_b32 v31, 0
    v_mov_b32 v32, 0
    v_mov_b32 v33, 0
    v_mov_b32 v34, 0
    v_mov_b32 v35, 0
    v_mov_b32 v36, 0
    v_mov_b32 v37, 0
    v_mov_b32 v38, 0
    v_mov_b32 v39, 0
    v_mov_b32 v40, 0
    v_mov_b32 v41, 0
    v_mov_b32 v42, 0
    v_mov_b32 v43, 0
    v_mov_b32 v44, 0
    v_mov_b32 v45, 0
    v_mov_b32 v46, 0
    v_mov_b32 v47, 0
L_v_nop:
    ds_read_b128 v[64:67], v11 offset:0
    ds_read_b128 v[68:71], v11 offset:512
    ds_read_b128 v[72:75], v11 offset:1024
    ds_read_b128 v[76:79], v11 offset:1536
    v_add_u32 v11, 2048, v11
    s_add_u32 s66, s82, 5
    s_bfe_u32 s64, s66, 0x10001
    s_lshl_b32 s64, s64, 26
    s_and_b32 s65, s66, 1
    s_lshl_b32 s65, s65, 17
    s_add_u32 s81, s80, s64
    s_add_u32 s81, s81, s65
    s_waitcnt lgkmcnt(0)
    s_cmp_eq_u32 s82, 3
    s_cbranch_scc0 L_v_w_14
    s_waitcnt vmcnt(24)
L_v_w_14:
    v_perm_b32 v52, v132, v128, s78
    v_perm_b32 v53, v140, v136, s78
    v_perm_b32 v54, v148, v144, s78
    v_perm_b32 v55, v156, v152, s78
    v_perm_b32 v56, v132, v128, s79
    v_perm_b32 v57, v140, v136, s79
    v_perm_b32 v58, v148, v144, s79
    v_perm_b32 v59, v156, v152, s79
    v_mfma_f32_16x16x32_bf16 v[16:19], v[64:67], v[52:55], v[16:19]
    v_perm_b32 v52, v133, v129, s78
    v_mfma_f32_16x16x32_bf16 v[20:23], v[64:67], v[56:59], v[20:23]
    v_perm_b32 v53, v141, v137, s78
    v_perm_b32 v54, v149, v145, s78
    v_perm_b32 v55, v157, v153, s78
    v_perm_b32 v56, v133, v129, s79
    v_perm_b32 v57, v141, v137, s79
    v_perm_b32 v58, v149, v145, s79
    v_perm_b32 v59, v157, v153, s79
    v_mfma_f32_16x16x32_bf16 v[24:27], v[64:67], v[52:55], v[24:27]
    v_perm_b32 v52, v134, v130, s78
    v_mfma_f32_16x16x32_bf16 v[28:31], v[64:67], v[56:59], v[28:31]
    v_perm_b32 v53, v142, v138, s78
    v_perm_b32 v54, v150, v146, s78
    v_perm_b32 v55, v158, v154, s78
    v_perm_b32 v56, v134, v130, s79
    v_perm_b32 v57, v142, v138, s79
    v_perm_b32 v58, v150, v146, s79
    v_perm_b32 v59, v158, v154, s79
    v_mfma_f32_16x16x32_bf16 v[32:35], v[64:67], v[52:55], v[32:35]
    v_perm_b32 v52, v135, v131, s78
    v_mfma_f32_16x16x32_bf16 v[36:39], v[64:67], v[56:59], v[36:39]
    v_perm_b32 v53, v143, v139, s78
    v_perm_b32 v54, v151, v147, s78
    v_perm_b32 v55, v159, v155, s78
    v_perm_b32 v56, v135, v131, s79
    v_perm_b32 v57, v143, v139, s79
    v_perm_b32 v58, v151, v147, s79
    v_perm_b32 v59, v159, v155, s79
    v_mfma_f32_16x16x32_bf16 v[40:43], v[64:67], v[52:55], v[40:43]
    s_nop 0
    v_mfma_f32_16x16x32_bf16 v[44:47], v[64:67], v[56:59], v[44:47]
    s_cmp_eq_u32 s82, 3
    s_cbranch_scc1 L_v_s_15
    s_waitcnt vmcnt(7)
    buffer_load_dwordx4 v[128:131], v96, s[44:47], s81 offen nt
    s_waitcnt vmcnt(7)
    buffer_load_dwordx4 v[132:135], v97, s[44:47], s81 offen nt
    s_waitcnt vmcnt(7)
    buffer_load_dwordx4 v[136:139], v98, s[44:47], s81 offen nt
    s_waitcnt vmcnt(7)
    buffer_load_dwordx4 v[140:143], v99, s[44:47], s81 offen nt
    s_waitcnt vmcnt(7)
    buffer_load_dwordx4 v[144:147], v100, s[44:47], s81 offen nt
    s_waitcnt vmcnt(7)
    buffer_load_dwordx4 v[148:151], v101, s[44:47], s81 offen nt
    s_waitcnt vmcnt(7)
    buffer_load_dwordx4 v[152:155], v102, s[44:47], s81 offen nt
    s_waitcnt vmcnt(7)
    buffer_load_dwordx4 v[156:159], v103, s[44:47], s81 offen nt
    s_add_u32 s81, s81, 32768
L_v_s_15:
    s_cmp_eq_u32 s82, 3
    s_cbranch_scc0 L_v_w_16
    s_waitcnt vmcnt(16)
L_v_w_16:
    v_perm_b32 v52, v164, v160, s78
    v_perm_b32 v53, v172, v168, s78
    v_perm_b32 v54, v180, v176, s78
    v_perm_b32 v55, v188, v184, s78
    v_perm_b32 v56, v164, v160, s79
    v_perm_b32 v57, v172, v168, s79
    v_perm_b32 v58, v180, v176, s79
    v_perm_b32 v59, v188, v184, s79
    v_mfma_f32_16x16x32_bf16 v[16:19], v[68:71], v[52:55], v[16:19]
    v_perm_b32 v52, v165, v161, s78
    v_mfma_f32_16x16x32_bf16 v[20:23], v[68:71], v[56:59], v[20:23]
    v_perm_b32 v53, v173, v169, s78
    v_perm_b32 v54, v181, v177, s78
    v_perm_b32 v55, v189, v185, s78
    v_perm_b32 v56, v165, v161, s79
    v_perm_b32 v57, v173, v169, s79
    v_perm_b32 v58, v181, v177, s79
    v_perm_b32 v59, v189, v185, s79
    v_mfma_f32_16x16x32_bf16 v[24:27], v[68:71], v[52:55], v[24:27]
    v_perm_b32 v52, v166, v162, s78
    v_mfma_f32_16x16x32_bf16 v[28:31], v[68:71], v[56:59], v[28:31]
    v_perm_b32 v53, v174, v170, s78
    v_perm_b32 v54, v182, v178, s78
    v_perm_b32 v55, v190, v186, s78
    v_perm_b32 v56, v166, v162, s79
    v_perm_b32 v57, v174, v170, s79
    v_perm_b32 v58, v182, v178, s79
    v_perm_b32 v59, v190, v186, s79
    v_mfma_f32_16x16x32_bf16 v[32:35], v[68:71], v[52:55], v[32:35]
    v_perm_b32 v52, v167, v163, s78
    v_mfma_f32_16x16x32_bf16 v[36:39], v[68:71], v[56:59], v[36:39]
    v_perm_b32 v53, v175, v171, s78
    v_perm_b32 v54, v183, v179, s78
    v_perm_b32 v55, v191, v187, s78
    v_perm_b32 v56, v167, v163, s79
    v_perm_b32 v57, v175, v171, s79
    v_perm_b32 v58, v183, v179, s79
    v_perm_b32 v59, v191, v187, s79
    v_mfma_f32_16x16x32_bf16 v[40:43], v[68:71], v[52:55], v[40:43]
    s_nop 0
    v_mfma_f32_16x16x32_bf16 v[44:47], v[68:71], v[56:59], v[44:47]
    s_cmp_eq_u32 s82, 0
    s_cbranch_scc0 L_v_h_17
    ds_add_u32 v13, v14 offset:56
L_v_h_17:
    s_cmp_eq_u32 s82, 3
    s_cbranch_scc1 L_v_s_18
    s_waitcnt vmcnt(7)
    buffer_load_dwordx4 v[160:163], v96, s[44:47], s81 offen nt
    s_waitcnt vmcnt(7)
    buffer_load_dwordx4 v[164:167], v97, s[44:47], s81 offen nt
    s_waitcnt vmcnt(7)
    buffer_load_dwordx4 v[168:171], v98, s[44:47], s81 offen nt
    s_waitcnt vmcnt(7)
    buffer_load_dwordx4 v[172:175], v99, s[44:47], s81 offen nt
    s_waitcnt vmcnt(7)
    buffer_load_dwordx4 v[176:179], v100, s[44:47], s81 offen nt
    s_waitcnt vmcnt(7)
    buffer_load_dwordx4 v[180:183], v101, s[44:47], s81 offen nt
    s_waitcnt vmcnt(7)
    buffer_load_dwordx4 v[184:187], v102, s[44:47], s81 offen nt
    s_waitcnt vmcnt(7)
    buffer_load_dwordx4 v[188:191], v103, s[44:47], s81 offen nt
    s_add_u32 s81, s81, 32768
L_v_s_18:
    s_cmp_eq_u32 s82, 3
    s_cbranch_scc0 L_v_w_19
    s_waitcnt vmcnt(8)
L_v_w_19:
    v_perm_b32 v52, v196, v192, s78
    v_perm_b32 v53, v204, v200, s78
    v_perm_b32 v54, v212, v208, s78
    v_perm_b32 v55, v220, v216, s78
    v_perm_b32 v56, v196, v192, s79
    v_perm_b32 v57, v204, v200, s79
    v_perm_b32 v58, v212, v208, s79
    v_perm_b32 v59, v220, v216, s79
    v_mfma_f32_16x16x32_bf16 v[16:19], v[72:75], v[52:55], v[16:19]
    v_perm_b32 v52, v197, v193, s78
    v_mfma_f32_16x16x32_bf16 v[20:23], v[72:75], v[56:59], v[20:23]
    v_perm_b32 v53, v205, v201, s78
    v_perm_b32 v54, v213, v209, s78
    v_perm_b32 v55, v221, v217, s78
    v_perm_b32 v56, v197, v193, s79
    v_perm_b32 v57, v205, v201, s79
    v_perm_b32 v58, v213, v209, s79
    v_perm_b32 v59, v221, v217, s79
    v_mfma_f32_16x16x32_bf16 v[24:27], v[72:75], v[52:55], v[24:27]
    v_perm_b32 v52, v198, v194, s78
    v_mfma_f32_16x16x32_bf16 v[28:31], v[72:75], v[56:59], v[28:31]
    v_perm_b32 v53, v206, v202, s78
    v_perm_b32 v54, v214, v210, s78
    v_perm_b32 v55, v222, v218, s78
    v_perm_b32 v56, v198, v194, s79
    v_perm_b32 v57, v206, v202, s79
    v_perm_b32 v58, v214, v210, s79
    v_perm_b32 v59, v222, v218, s79
    v_mfma_f32_16x16x32_bf16 v[32:35], v[72:75], v[52:55], v[32:35]
    v_perm_b32 v52, v199, v195, s78
    v_mfma_f32_16x16x32_bf16 v[36:39], v[72:75], v[56:59], v[36:39]
    v_perm_b32 v53, v207, v203, s78
    v_perm_b32 v54, v215, v211, s78
    v_perm_b32 v55, v223, v219, s78
    v_perm_b32 v56, v199, v195, s79
    v_perm_b32 v57, v207, v203, s79
    v_perm_b32 v58, v215, v211, s79
    v_perm_b32 v59, v223, v219, s79
    v_mfma_f32_16x16x32_bf16 v[40:43], v[72:75], v[52:55], v[40:43]
    s_nop 0
    v_mfma_f32_16x16x32_bf16 v[44:47], v[72:75], v[56:59], v[44:47]
    s_cmp_eq_u32 s82, 3
    s_cbranch_scc1 L_v_s_20
    s_waitcnt vmcnt(7)
    buffer_load_dwordx4 v[192:195], v96, s[44:47], s81 offen nt
    s_waitcnt vmcnt(7)
    buffer_load_dwordx4 v[196:199], v97, s[44:47], s81 offen nt
    s_waitcnt vmcnt(7)
    buffer_load_dwordx4 v[200:203], v98, s[44:47], s81 offen nt
    s_waitcnt vmcnt(7)
    buffer_load_dwordx4 v[204:207], v99, s[44:47], s81 offen nt
    s_waitcnt vmcnt(7)
    buffer_load_dwordx4 v[208:211], v100, s[44:47], s81 offen nt
    s_waitcnt vmcnt(7)
    buffer_load_dwordx4 v[212:215], v101, s[44:47], s81 offen nt
    s_waitcnt vmcnt(7)
    buffer_load_dwordx4 v[216:219], v102, s[44:47], s81 offen nt
    s_waitcnt vmcnt(7)
    buffer_load_dwordx4 v[220:223], v103, s[44:47], s81 offen nt
    s_add_u32 s81, s81, 32768
L_v_s_20:
    s_cmp_eq_u32 s82, 3
    s_cbranch_scc0 L_v_w_21
    s_waitcnt vmcnt(0)
L_v_w_21:
    v_perm_b32 v52, v228, v224, s78
    v_perm_b32 v53, v236, v232, s78
    v_perm_b32 v54, v244, v240, s78
    v_perm_b32 v55, v252, v248, s78
    v_perm_b32 v56, v228, v224, s79
    v_perm_b32 v57, v236, v232, s79
    v_perm_b32 v58, v244, v240, s79
    v_perm_b32 v59, v252, v248, s79
    v_mfma_f32_16x16x32_bf16 v[16:19], v[76:79], v[52:55], v[16:19]
    v_perm_b32 v52, v229, v225, s78
    v_mfma_f32_16x16x32_bf16 v[20:23], v[76:79], v[56:59], v[20:23]
    v_perm_b32 v53, v237, v233, s78
    v_perm_b32 v54, v245, v241, s78
    v_perm_b32 v55, v253, v249, s78
    v_perm_b32 v56, v229, v225, s79
    v_perm_b32 v57, v237, v233, s79
    v_perm_b32 v58, v245, v241, s79
    v_perm_b32 v59, v253, v249, s79
    v_mfma_f32_16x16x32_bf16 v[24:27], v[76:79], v[52:55], v[24:27]
    v_perm_b32 v52, v230, v226, s78
    v_mfma_f32_16x16x32_bf16 v[28:31], v[76:79], v[56:59], v[28:31]
    v_perm_b32 v53, v238, v234, s78
    v_perm_b32 v54, v246, v242, s78
    v_perm_b32 v55, v254, v250, s78
    v_perm_b32 v56, v230, v226, s79
    v_perm_b32 v57, v238, v234, s79
    v_perm_b32 v58, v246, v242, s79
    v_perm_b32 v59, v254, v250, s79
    v_mfma_f32_16x16x32_bf16 v[32:35], v[76:79], v[52:55], v[32:35]
    v_perm_b32 v52, v231, v227, s78
    v_mfma_f32_16x16x32_bf16 v[36:39], v[76:79], v[56:59], v[36:39]
    v_perm_b32 v53, v239, v235, s78
    v_perm_b32 v54, v247, v243, s78
    v_perm_b32 v55, v255, v251, s78
    v_perm_b32 v56, v231, v227, s79
    v_perm_b32 v57, v239, v235, s79
    v_perm_b32 v58, v247, v243, s79
    v_perm_b32 v59, v255, v251, s79
    v_mfma_f32_16x16x32_bf16 v[40:43], v[76:79], v[52:55], v[40:43]
    s_nop 0
    v_mfma_f32_16x16x32_bf16 v[44:47], v[76:79], v[56:59], v[44:47]
    s_cmp_eq_u32 s82, 3
    s_cbranch_scc1 L_v_s_22
    s_waitcnt vmcnt(7)
    buffer_load_dwordx4 v[224:227], v96, s[44:47], s81 offen nt
    s_waitcnt vmcnt(7)
    buffer_load_dwordx4 v[228:231], v97, s[44:47], s81 offen nt
    s_waitcnt vmcnt(7)
    buffer_load_dwordx4 v[232:235], v98, s[44:47], s81 offen nt
    s_waitcnt vmcnt(7)
    buffer_load_dwordx4 v[236:239], v99, s[44:47], s81 offen nt
    s_waitcnt vmcnt(7)
    buffer_load_dwordx4 v[240:243], v100, s[44:47], s81 offen nt
    s_waitcnt vmcnt(7)
    buffer_load_dwordx4 v[244:247], v101, s[44:47], s81 offen nt
    s_waitcnt vmcnt(7)
    buffer_load_dwordx4 v[248:251], v102, s[44:47], s81 offen nt
    s_waitcnt vmcnt(7)
    buffer_load_dwordx4 v[252:255], v103, s[44:47], s81 offen nt
    s_add_u32 s81, s81, 32768
L_v_s_22:
    s_and_b32 s64, s82, 1
    s_cmp_eq_u32 s64, 0
    s_cbranch_scc1 L_v_noout
    s_mov_b64 exec, 0xffff
    ds_write2_b32 v12, v16, v20 offset0:0 offset1:1
    ds_write2_b32 v12, v24, v28 offset0:2 offset1:3
    ds_write2_b32 v12, v32, v36 offset0:4 offset1:5
    ds_write2_b32 v12, v40, v44 offset0:6 offset1:7
    ds_write2_b32 v12, v17, v21 offset0:128 offset1:129
    ds_write2_b32 v12, v25, v29 offset0:130 offset1:131
    ds_write2_b32 v12, v33, v37 offset0:132 offset1:133
    ds_write2_b32 v12, v41, v45 offset0:134 offset1:135
    s_mov_b64 exec, -1
    ds_add_u32 v5, v14 offset:24
    v_add_u32 v5, 4, v5
    v_add_u32 v12, 0x1000, v12
L_v_noout:
    ds_add_u32 v13, v14 offset:44
    s_add_u32 s82, s82, 1
    s_cmp_lt_u32 s82, 4
    s_cbranch_scc1 L_vloop
    s_endpgm
L_ctrl:
    s_sub_u32 s12, s3, 4
    s_mov_b32 s13, 0
    s_mov_b32 s14, 0
    s_mov_b32 s44, s42
    s_mov_b32 s45, s43
    s_mov_b32 s46, 2953216
    s_mov_b32 s47, 0x20000
    s_mov_b32 s48, s42
    s_mov_b32 s49, s43
    s_mov_b32 s50, 2953216
    s_mov_b32 s51, 0x20000
    v_mov_b32 v7, 147456
    v_mov_b32 v8, 1
    s_cmp_eq_u32 s12, 0
    s_cbranch_scc1 L_c_w0a
    s_cmp_eq_u32 s12, 3
    s_cbranch_scc1 L_c_w3a
    s_cmp_eq_u32 s6, 1
    s_cbranch_scc1 L_c_dmd
    s_cmp_eq_u32 s8, -1
    s_cbranch_scc1 L_c_dm
    s_mov_b32 s52, s22
    s_mov_b32 s53, s23
    s_mov_b32 s54, 4718592
    s_mov_b32 s55, 0x20000
    v_lshrrev_b32 v9, 3, v1
    v_and_b32 v15, 3, v9
    v_lshlrev_b32 v15, 1, v15
    v_and_b32 v56, 7, v1
    v_xor_b32 v15, v15, v56
    v_xor_b32 v56, 2, v15
    v_mul_u32_u24 v9, 8192, v9
    v_lshlrev_b32 v15, 4, v15
    v_lshlrev_b32 v56, 4, v56
    v_add_u32 v56, v9, v56
    v_add_u32 v9, v9, v15
    s_sub_u32 s67, s12, 1
    s_mul_i32 s64, s67, 2359296
    s_lshl_b32 s65, s8, 7
    s_add_u32 s64, s64, s65
    s_mul_i32 s65, s67, 36864
    s_add_u32 s65, s65, 73728
    s_mov_b32 s66, 18
L_cdma_23:
    s_mov_b32 m0, s65
    s_add_u32 s65, s65, 1024
    s_waitcnt vmcnt(35)
    buffer_load_dwordx4 v9, s[52:55], s64 offen nt lds
    s_add_u32 s64, s64, 65536
    s_mov_b32 m0, s65
    s_add_u32 s65, s65, 1024
    s_waitcnt vmcnt(35)
    buffer_load_dwordx4 v56, s[52:55], s64 offen nt lds
    s_add_u32 s64, s64, 65536
    s_sub_u32 s66, s66, 1
    s_cmp_lg_u32 s66, 0
    s_cbranch_scc1 L_cdma_23
    s_branch L_c_dmd
L_c_dm:
    s_mov_b32 s52, s36
    s_mov_b32 s53, s37
    s_mov_b32 s54, 3981312
    s_mov_b32 s55, 0x20000
    v_lshrrev_b32 v9, 3, v1
    v_and_b32 v15, 3, v9
    v_lshlrev_b32 v15, 1, v15
    v_and_b32 v56, 7, v1
    v_xor_b32 v15, v15, v56
    v_xor_b32 v56, 2, v15
    v_mul_u32_u24 v9, 6912, v9
    v_lshlrev_b32 v15, 4, v15
    v_lshlrev_b32 v56, 4, v56
    v_add_u32 v56, v9, v56
    v_add_u32 v9, v9, v15
    s_sub_u32 s67, s12, 1
    s_mul_i32 s64, s67, 1990656
    s_add_u32 s65, s9, 0
    s_lshl_b32 s65, s65, 7
    s_add_u32 s64, s64, s65
    s_mul_i32 s65, s67, 36864
    s_add_u32 s65, s65, 73728
    s_mov_b32 s66, 18
L_cdma_24:
    s_mov_b32 m0, s65
    s_add_u32 s65, s65, 1024
    s_waitcnt vmcnt(35)
    buffer_load_dwordx4 v9, s[52:55], s64 offen nt lds
    s_add_u32 s64, s64, 55296
    s_mov_b32 m0, s65
    s_add_u32 s65, s65, 1024
    s_waitcnt vmcnt(35)
    buffer_load_dwordx4 v56, s[52:55], s64 offen nt lds
    s_add_u32 s64, s64, 55296
    s_sub_u32 s66, s66, 1
    s_cmp_lg_u32 s66, 0
    s_cbranch_scc1 L_cdma_24
L_c_dmd:
    s_barrier
    s_branch L_c_common
L_c_w0a:
    v_lshrrev_b32 v9, 5, v1
    v_mul_u32_u24 v9, 1152, v9
    v_and_b32 v10, 31, v1
    v_mul_u32_u24 v10, 36, v10
    v_add_u32 v2, v9, v10
    s_cmp_eq_u32 s9, -1
    s_cselect_b32 s52, s16, s34
    s_cselect_b32 s53, s17, s35
    s_mov_b32 s54, 2304
    s_mov_b32 s55, 0x20000
    buffer_load_dwordx4 v[56:59], v2, s[52:55], 0 offen
    buffer_load_dwordx4 v[60:63], v2, s[52:55], 0 offen offset:16
    buffer_load_dword v64, v2, s[52:55], 0 offen offset:32
    v_mov_b32 v9, 28672
    buffer_load_dword v110, v9, s[44:47], 0 offen sc1
    v_and_b32 v9, 31, v1
    v_lshlrev_b32 v9, 2, v9
    v_add_u32 v9, 147456, v9
    v_mov_b32 v10, 0
    ds_write_b32 v9, v10
    s_waitcnt lgkmcnt(0)
    s_barrier
    s_branch L_c_common
L_c_w3a:
    s_barrier
L_c_common:
    v_lshrrev_b32 v9, 5, v1
    v_mul_u32_u24 v9, 1152, v9
    v_and_b32 v13, 31, v1
    v_mul_u32_u24 v10, 36, v13
    v_add_u32 v2, v9, v10
    v_lshrrev_b32 v9, 4, v1
    v_bfe_u32 v10, v1, 2, 2
    v_lshlrev_b32 v11, 3, v9
    v_add_u32 v10, v10, v11
    v_and_b32 v11, 3, v1
    v_lshlrev_b32 v11, 3, v11
    v_lshlrev_b32 v3, 6, v10
    v_add_u32 v3, v3, v11
    v_mul_u32_u24 v4, 1152, v10
    v_add_u32 v4, v4, v11
    v_and_b32 v10, 1, v1
    v_lshlrev_b32 v9, 4, v9
    v_mul_u32_u24 v5, 1152, v10
    v_add_u32 v5, v5, v9
    v_lshlrev_b32 v6, 6, v10
    v_add_u32 v6, v6, v9
    v_mov_b32 v14, -2
    v_bfe_u32 v9, v1, 2, 2
    v_cmp_eq_u32 s[70:71], 0, v9
    v_cmp_eq_u32 s[72:73], 1, v9
    v_cmp_eq_u32 s[74:75], 2, v9
    v_cmp_eq_u32 s[76:77], 3, v9
    s_mov_b32 s65, 28672
    s_cmp_eq_u32 s6, 1
    s_cselect_b32 s65, 36864, s65
    s_mul_i32 s64, s12, 144
    v_add_u32 v9, s64, v1
    v_lshrrev_b32 v15, 5, v9
    v_mul_lo_u32 v15, s65, v15
    v_and_b32 v9, 31, v9
    v_lshlrev_b32 v9, 2, v9
    v_add_u32 v10, v9, v15
    v_add_u32 v9, s64, v1
    v_add_u32 v9, 64, v9
    v_lshrrev_b32 v15, 5, v9
    v_mul_lo_u32 v15, s65, v15
    v_and_b32 v9, 31, v9
    v_lshlrev_b32 v9, 2, v9
    v_add_u32 v11, v9, v15
    v_add_u32 v9, s64, v1
    v_add_u32 v9, 128, v9
    v_lshrrev_b32 v15, 5, v9
    v_mul_lo_u32 v15, s65, v15
    v_and_b32 v9, 31, v9
    v_lshlrev_b32 v9, 2, v9
    v_add_u32 v12, v9, v15
    s_branch L_subs_end
SUB_LN:
    v_lshlrev_b32 v66, 16, v56
    v_and_b32 v67, 0xffff0000, v56
    v_lshlrev_b32 v68, 16, v57
    v_and_b32 v69, 0xffff0000, v57
    v_lshlrev_b32 v70, 16, v58
    v_and_b32 v71, 0xffff0000, v58
    v_lshlrev_b32 v72, 16, v59
    v_and_b32 v73, 0xffff0000, v59
    v_lshlrev_b32 v74, 16, v60
    v_and_b32 v75, 0xffff0000, v60
    v_lshlrev_b32 v76, 16, v61
    v_and_b32 v77, 0xffff0000, v61
    v_lshlrev_b32 v78, 16, v62
    v_and_b32 v79, 0xffff0000, v62
    v_lshlrev_b32 v80, 16, v63
    v_and_b32 v81, 0xffff0000, v63
    v_lshlrev_b32 v82, 16, v64
    v_and_b32 v83, 0xffff0000, v64
    v_add_f32 v84, v66, v67
    v_add_f32 v84, v84, v68
    v_add_f32 v84, v84, v69
    v_add_f32 v84, v84, v70
    v_add_f32 v84, v84, v71
    v_add_f32 v84, v84, v72
    v_add_f32 v84, v84, v73
    v_add_f32 v84, v84, v74
    v_add_f32 v84, v84, v75
    v_add_f32 v84, v84, v76
    v_add_f32 v84, v84, v77
    v_add_f32 v84, v84, v78
    v_add_f32 v84, v84, v79
    v_add_f32 v84, v84, v80
    v_add_f32 v84, v84, v81
    v_add_f32 v84, v84, v82
    v_add_f32 v84, v84, v83
    s_nop 1
    v_add_f32_dpp v84, v84, v84 row_ror:8 row_mask:0xf bank_mask:0xf
    s_nop 1
    v_add_f32_dpp v84, v84, v84 row_ror:4 row_mask:0xf bank_mask:0xf
    s_nop 1
    v_add_f32_dpp v84, v84, v84 row_ror:2 row_mask:0xf bank_mask:0xf
    s_nop 1
    v_add_f32_dpp v84, v84, v84 row_ror:1 row_mask:0xf bank_mask:0xf
    v_mov_b32 v85, v84
    s_nop 1
    v_permlane16_swap_b32 v84, v85
    v_add_f32 v84, v84, v85
    v_mul_f32 v84, 0x3ae38e39, v84
    v_mov_b32 v86, 0
    v_sub_f32 v87, v66, v84
    v_fmac_f32 v86, v87, v87
    v_sub_f32 v87, v67, v84
    v_fmac_f32 v86, v87, v87
    v_sub_f32 v87, v68, v84
    v_fmac_f32 v86, v87, v87
    v_sub_f32 v87, v69, v84
    v_fmac_f32 v86, v87, v87
    v_sub_f32 v87, v70, v84
    v_fmac_f32 v86, v87, v87
    v_sub_f32 v87, v71, v84
    v_fmac_f32 v86, v87, v87
    v_sub_f32 v87, v72, v84
    v_fmac_f32 v86, v87, v87
    v_sub_f32 v87, v73, v84
    v_fmac_f32 v86, v87, v87
    v_sub_f32 v87, v74, v84
    v_fmac_f32 v86, v87, v87
    v_sub_f32 v87, v75, v84
    v_fmac_f32 v86, v87, v87
    v_sub_f32 v87, v76, v84
    v_fmac_f32 v86, v87, v87
    v_sub_f32 v87, v77, v84
    v_fmac_f32 v86, v87, v87
    v_sub_f32 v87, v78, v84
    v_fmac_f32 v86, v87, v87
    v_sub_f32 v87, v79, v84
    v_fmac_f32 v86, v87, v87
    v_sub_f32 v87, v80, v84
    v_fmac_f32 v86, v87, v87
    v_sub_f32 v87, v81, v84
    v_fmac_f32 v86, v87, v87
    v_sub_f32 v87, v82, v84
    v_fmac_f32 v86, v87, v87
    v_sub_f32 v87, v83, v84
    v_fmac_f32 v86, v87, v87
    s_nop 1
    v_add_f32_dpp v86, v86, v86 row_ror:8 row_mask:0xf bank_mask:0xf
    s_nop 1
    v_add_f32_dpp v86, v86, v86 row_ror:4 row_mask:0xf bank_mask:0xf
    s_nop 1
    v_add_f32_dpp v86, v86, v86 row_ror:2 row_mask:0xf bank_mask:0xf
    s_nop 1
    v_add_f32_dpp v86, v86, v86 row_ror:1 row_mask:0xf bank_mask:0xf
    v_mov_b32 v85, v86
    s_nop 1
    v_permlane16_swap_b32 v86, v85
    v_add_f32 v86, v86, v85
    v_mul_f32 v86, 0x3ae38e39, v86
    v_cvt_pk_bf16_f32 v85, v84, v86
    v_lshlrev_b32 v84, 16, v85
    v_and_b32 v86, 0xffff0000, v85
    v_add_f32 v86, 0x3727c5ac, v86
    v_cvt_pk_bf16_f32 v85, v86, v86
    v_and_b32 v86, 0xffff0000, v85
    v_sqrt_f32 v86, v86
    s_nop 0
    v_cvt_pk_bf16_f32 v85, v86, v86
    v_and_b32 v86, 0xffff0000, v85
    v_rcp_f32 v87, v86
    v_sub_f32 v66, v66, v84
    v_sub_f32 v67, v67, v84
    v_cvt_pk_bf16_f32 v85, v66, v67
    v_lshlrev_b32 v66, 16, v85
    v_and_b32 v67, 0xffff0000, v85
    v_mul_f32 v88, v66, v87
    v_fma_f32 v89, -v88, v86, v66
    v_fma_f32 v66, v89, v87, v88
    v_mul_f32 v88, v67, v87
    v_fma_f32 v89, -v88, v86, v67
    v_fma_f32 v67, v89, v87, v88
    v_cvt_pk_bf16_f32 v85, v66, v67
    v_lshlrev_b32 v66, 16, v85
    v_and_b32 v67, 0xffff0000, v85
    v_sub_f32 v68, v68, v84
    v_sub_f32 v69, v69, v84
    v_cvt_pk_bf16_f32 v85, v68, v69
    v_lshlrev_b32 v68, 16, v85
    v_and_b32 v69, 0xffff0000, v85
    v_mul_f32 v88, v68, v87
    v_fma_f32 v89, -v88, v86, v68
    v_fma_f32 v68, v89, v87, v88
    v_mul_f32 v88, v69, v87
    v_fma_f32 v89, -v88, v86, v69
    v_fma_f32 v69, v89, v87, v88
    v_cvt_pk_bf16_f32 v85, v68, v69
    v_lshlrev_b32 v68, 16, v85
    v_and_b32 v69, 0xffff0000, v85
    v_sub_f32 v70, v70, v84
    v_sub_f32 v71, v71, v84
    v_cvt_pk_bf16_f32 v85, v70, v71
    v_lshlrev_b32 v70, 16, v85
    v_and_b32 v71, 0xffff0000, v85
    v_mul_f32 v88, v70, v87
    v_fma_f32 v89, -v88, v86, v70
    v_fma_f32 v70, v89, v87, v88
    v_mul_f32 v88, v71, v87
    v_fma_f32 v89, -v88, v86, v71
    v_fma_f32 v71, v89, v87, v88
    v_cvt_pk_bf16_f32 v85, v70, v71
    v_lshlrev_b32 v70, 16, v85
    v_and_b32 v71, 0xffff0000, v85
    v_sub_f32 v72, v72, v84
    v_sub_f32 v73, v73, v84
    v_cvt_pk_bf16_f32 v85, v72, v73
    v_lshlrev_b32 v72, 16, v85
    v_and_b32 v73, 0xffff0000, v85
    v_mul_f32 v88, v72, v87
    v_fma_f32 v89, -v88, v86, v72
    v_fma_f32 v72, v89, v87, v88
    v_mul_f32 v88, v73, v87
    v_fma_f32 v89, -v88, v86, v73
    v_fma_f32 v73, v89, v87, v88
    v_cvt_pk_bf16_f32 v85, v72, v73
    v_lshlrev_b32 v72, 16, v85
    v_and_b32 v73, 0xffff0000, v85
    v_sub_f32 v74, v74, v84
    v_sub_f32 v75, v75, v84
    v_cvt_pk_bf16_f32 v85, v74, v75
    v_lshlrev_b32 v74, 16, v85
    v_and_b32 v75, 0xffff0000, v85
    v_mul_f32 v88, v74, v87
    v_fma_f32 v89, -v88, v86, v74
    v_fma_f32 v74, v89, v87, v88
    v_mul_f32 v88, v75, v87
    v_fma_f32 v89, -v88, v86, v75
    v_fma_f32 v75, v89, v87, v88
    v_cvt_pk_bf16_f32 v85, v74, v75
    v_lshlrev_b32 v74, 16, v85
    v_and_b32 v75, 0xffff0000, v85
    v_sub_f32 v76, v76, v84
    v_sub_f32 v77, v77, v84
    v_cvt_pk_bf16_f32 v85, v76, v77
    v_lshlrev_b32 v76, 16, v85
    v_and_b32 v77, 0xffff0000, v85
    v_mul_f32 v88, v76, v87
    v_fma_f32 v89, -v88, v86, v76
    v_fma_f32 v76, v89, v87, v88
    v_mul_f32 v88, v77, v87
    v_fma_f32 v89, -v88, v86, v77
    v_fma_f32 v77, v89, v87, v88
    v_cvt_pk_bf16_f32 v85, v76, v77
    v_lshlrev_b32 v76, 16, v85
    v_and_b32 v77, 0xffff0000, v85
    v_sub_f32 v78, v78, v84
    v_sub_f32 v79, v79, v84
    v_cvt_pk_bf16_f32 v85, v78, v79
    v_lshlrev_b32 v78, 16, v85
    v_and_b32 v79, 0xffff0000, v85
    v_mul_f32 v88, v78, v87
    v_fma_f32 v89, -v88, v86, v78
    v_fma_f32 v78, v89, v87, v88
    v_mul_f32 v88, v79, v87
    v_fma_f32 v89, -v88, v86, v79
    v_fma_f32 v79, v89, v87, v88
    v_cvt_pk_bf16_f32 v85, v78, v79
    v_lshlrev_b32 v78, 16, v85
    v_and_b32 v79, 0xffff0000, v85
    v_sub_f32 v80, v80, v84
    v_sub_f32 v81, v81, v84
    v_cvt_pk_bf16_f32 v85, v80, v81
    v_lshlrev_b32 v80, 16, v85
    v_and_b32 v81, 0xffff0000, v85
    v_mul_f32 v88, v80, v87
    v_fma_f32 v89, -v88, v86, v80
    v_fma_f32 v80, v89, v87, v88
    v_mul_f32 v88, v81, v87
    v_fma_f32 v89, -v88, v86, v81
    v_fma_f32 v81, v89, v87, v88
    v_cvt_pk_bf16_f32 v85, v80, v81
    v_lshlrev_b32 v80, 16, v85
    v_and_b32 v81, 0xffff0000, v85
    v_sub_f32 v82, v82, v84
    v_sub_f32 v83, v83, v84
    v_cvt_pk_bf16_f32 v85, v82, v83
    v_lshlrev_b32 v82, 16, v85
    v_and_b32 v83, 0xffff0000, v85
    v_mul_f32 v88, v82, v87
    v_fma_f32 v89, -v88, v86, v82
    v_fma_f32 v82, v89, v87, v88
    v_mul_f32 v88, v83, v87
    v_fma_f32 v89, -v88, v86, v83
    v_fma_f32 v83, v89, v87, v88
    v_cvt_pk_bf16_f32 v85, v82, v83
    v_lshlrev_b32 v82, 16, v85
    v_and_b32 v83, 0xffff0000, v85
    s_setpc_b64 s[62:63]
SUB_PREP:
    v_lshrrev_b32 v88, 5, v1
    v_mul_u32_u24 v88, 2304, v88
    v_mul_u32_u24 v89, 72, v13
    v_add_u32 v88, v88, v89
    s_mov_b32 s68, 524288
    s_cmp_lg_u32 s14, 0
    s_cbranch_scc1 L_polltdsc_26
L_polltsc_25:
    buffer_load_dwordx4 v[90:93], v88, s[44:47], s80 offen offset:0 sc1
    buffer_load_dwordx4 v[94:97], v88, s[44:47], s80 offen offset:16 sc1
    buffer_load_dwordx4 v[98:101], v88, s[44:47], s80 offen offset:32 sc1
    buffer_load_dwordx4 v[102:105], v88, s[44:47], s80 offen offset:48 sc1
    buffer_load_dwordx2 v[106:107], v88, s[44:47], s80 offen offset:64 sc1
    buffer_load_dwordx4 v[108:111], v88, s[44:47], s81 offen offset:0 sc1
    buffer_load_dwordx4 v[112:115], v88, s[44:47], s81 offen offset:16 sc1
    buffer_load_dwordx4 v[116:119], v88, s[44:47], s81 offen offset:32 sc1
    buffer_load_dwordx4 v[120:123], v88, s[44:47], s81 offen offset:48 sc1
    buffer_load_dwordx2 v[124:125], v88, s[44:47], s81 offen offset:64 sc1
    s_waitcnt vmcnt(0)
    v_xor_b32 v9, s79, v91
    v_xor_b32 v93, s79, v93
    v_xor_b32 v95, s79, v95
    v_xor_b32 v97, s79, v97
    v_xor_b32 v99, s79, v99
    v_xor_b32 v101, s79, v101
    v_xor_b32 v103, s79, v103
    v_xor_b32 v105, s79, v105
    v_xor_b32 v107, s79, v107
    v_xor_b32 v109, s79, v109
    v_xor_b32 v111, s79, v111
    v_xor_b32 v113, s79, v113
    v_xor_b32 v115, s79, v115
    v_xor_b32 v117, s79, v117
    v_xor_b32 v119, s79, v119
    v_xor_b32 v121, s79, v121
    v_xor_b32 v123, s79, v123
    v_xor_b32 v125, s79, v125
    v_or3_b32 v9, v9, v93, v95
    v_or3_b32 v9, v9, v97, v99
    v_or3_b32 v9, v9, v101, v103
    v_or3_b32 v9, v9, v105, v107
    v_or3_b32 v9, v9, v109, v111
    v_or3_b32 v9, v9, v113, v115
    v_or3_b32 v9, v9, v117, v119
    v_or3_b32 v9, v9, v121, v123
    v_or_b32 v9, v9, v125
    v_cmp_ne_u32 vcc, 0, v9
    s_cbranch_vccz L_polltdsc_26
    s_sub_u32 s68, s68, 1
    s_cbranch_scc1 L_abort
    s_sleep 8
    s_branch L_polltsc_25
L_polltdsc_26:
    v_lshlrev_b32 v34, 16, v90
    v_and_b32 v35, 0xffff0000, v90
    v_lshlrev_b32 v16, 16, v108
    v_and_b32 v17, 0xffff0000, v108
    v_add_f32 v16, 1.0, v16
    v_add_f32 v17, 1.0, v17
    v_cvt_pk_bf16_f32 v89, v16, v17
    v_lshlrev_b32 v16, 16, v89
    v_and_b32 v17, 0xffff0000, v89
    v_lshlrev_b32 v36, 16, v92
    v_and_b32 v37, 0xffff0000, v92
    v_lshlrev_b32 v18, 16, v110
    v_and_b32 v19, 0xffff0000, v110
    v_add_f32 v18, 1.0, v18
    v_add_f32 v19, 1.0, v19
    v_cvt_pk_bf16_f32 v89, v18, v19
    v_lshlrev_b32 v18, 16, v89
    v_and_b32 v19, 0xffff0000, v89
    v_lshlrev_b32 v38, 16, v94
    v_and_b32 v39, 0xffff0000, v94
    v_lshlrev_b32 v20, 16, v112
    v_and_b32 v21, 0xffff0000, v112
    v_add_f32 v20, 1.0, v20
    v_add_f32 v21, 1.0, v21
    v_cvt_pk_bf16_f32 v89, v20, v21
    v_lshlrev_b32 v20, 16, v89
    v_and_b32 v21, 0xffff0000, v89
    v_lshlrev_b32 v40, 16, v96
    v_and_b32 v41, 0xffff0000, v96
    v_lshlrev_b32 v22, 16, v114
    v_and_b32 v23, 0xffff0000, v114
    v_add_f32 v22, 1.0, v22
    v_add_f32 v23, 1.0, v23
    v_cvt_pk_bf16_f32 v89, v22, v23
    v_lshlrev_b32 v22, 16, v89
    v_and_b32 v23, 0xffff0000, v89
    v_lshlrev_b32 v42, 16, v98
    v_and_b32 v43, 0xffff0000, v98
    v_lshlrev_b32 v24, 16, v116
    v_and_b32 v25, 0xffff0000, v116
    v_add_f32 v24, 1.0, v24
    v_add_f32 v25, 1.0, v25
    v_cvt_pk_bf16_f32 v89, v24, v25
    v_lshlrev_b32 v24, 16, v89
    v_and_b32 v25, 0xffff0000, v89
    v_lshlrev_b32 v44, 16, v100
    v_and_b32 v45, 0xffff0000, v100
    v_lshlrev_b32 v26, 16, v118
    v_and_b32 v27, 0xffff0000, v118
    v_add_f32 v26, 1.0, v26
    v_add_f32 v27, 1.0, v27
    v_cvt_pk_bf16_f32 v89, v26, v27
    v_lshlrev_b32 v26, 16, v89
    v_and_b32 v27, 0xffff0000, v89
    v_lshlrev_b32 v46, 16, v102
    v_and_b32 v47, 0xffff0000, v102
    v_lshlrev_b32 v28, 16, v120
    v_and_b32 v29, 0xffff0000, v120
    v_add_f32 v28, 1.0, v28
    v_add_f32 v29, 1.0, v29
    v_cvt_pk_bf16_f32 v89, v28, v29
    v_lshlrev_b32 v28, 16, v89
    v_and_b32 v29, 0xffff0000, v89
    v_lshlrev_b32 v48, 16, v104
    v_and_b32 v49, 0xffff0000, v104
    v_lshlrev_b32 v30, 16, v122
    v_and_b32 v31, 0xffff0000, v122
    v_add_f32 v30, 1.0, v30
    v_add_f32 v31, 1.0, v31
    v_cvt_pk_bf16_f32 v89, v30, v31
    v_lshlrev_b32 v30, 16, v89
    v_and_b32 v31, 0xffff0000, v89
    v_lshlrev_b32 v50, 16, v106
    v_and_b32 v51, 0xffff0000, v106
    v_lshlrev_b32 v32, 16, v124
    v_and_b32 v33, 0xffff0000, v124
    v_add_f32 v32, 1.0, v32
    v_add_f32 v33, 1.0, v33
    v_cvt_pk_bf16_f32 v89, v32, v33
    v_lshlrev_b32 v32, 16, v89
    v_and_b32 v33, 0xffff0000, v89
    s_setpc_b64 s[62:63]
SUB_MOD:
    v_mul_f32 v84, v66, v16
    v_mul_f32 v85, v67, v17
    v_cvt_pk_bf16_f32 v86, v84, v85
    v_lshlrev_b32 v84, 16, v86
    v_and_b32 v85, 0xffff0000, v86
    v_add_f32 v84, v84, v34
    v_add_f32 v85, v85, v35
    v_cvt_pk_bf16_f32 v56, v84, v85
    v_mul_f32 v84, v68, v18
    v_mul_f32 v85, v69, v19
    v_cvt_pk_bf16_f32 v86, v84, v85
    v_lshlrev_b32 v84, 16, v86
    v_and_b32 v85, 0xffff0000, v86
    v_add_f32 v84, v84, v36
    v_add_f32 v85, v85, v37
    v_cvt_pk_bf16_f32 v57, v84, v85
    v_mul_f32 v84, v70, v20
    v_mul_f32 v85, v71, v21
    v_cvt_pk_bf16_f32 v86, v84, v85
    v_lshlrev_b32 v84, 16, v86
    v_and_b32 v85, 0xffff0000, v86
    v_add_f32 v84, v84, v38
    v_add_f32 v85, v85, v39
    v_cvt_pk_bf16_f32 v58, v84, v85
    v_mul_f32 v84, v72, v22
    v_mul_f32 v85, v73, v23
    v_cvt_pk_bf16_f32 v86, v84, v85
    v_lshlrev_b32 v84, 16, v86
    v_and_b32 v85, 0xffff0000, v86
    v_add_f32 v84, v84, v40
    v_add_f32 v85, v85, v41
    v_cvt_pk_bf16_f32 v59, v84, v85
    v_mul_f32 v84, v74, v24
    v_mul_f32 v85, v75, v25
    v_cvt_pk_bf16_f32 v86, v84, v85
    v_lshlrev_b32 v84, 16, v86
    v_and_b32 v85, 0xffff0000, v86
    v_add_f32 v84, v84, v42
    v_add_f32 v85, v85, v43
    v_cvt_pk_bf16_f32 v60, v84, v85
    v_mul_f32 v84, v76, v26
    v_mul_f32 v85, v77, v27
    v_cvt_pk_bf16_f32 v86, v84, v85
    v_lshlrev_b32 v84, 16, v86
    v_and_b32 v85, 0xffff0000, v86
    v_add_f32 v84, v84, v44
    v_add_f32 v85, v85, v45
    v_cvt_pk_bf16_f32 v61, v84, v85
    v_mul_f32 v84, v78, v28
    v_mul_f32 v85, v79, v29
    v_cvt_pk_bf16_f32 v86, v84, v85
    v_lshlrev_b32 v84, 16, v86
    v_and_b32 v85, 0xffff0000, v86
    v_add_f32 v84, v84, v46
    v_add_f32 v85, v85, v47
    v_cvt_pk_bf16_f32 v62, v84, v85
    v_mul_f32 v84, v80, v30
    v_mul_f32 v85, v81, v31
    v_cvt_pk_bf16_f32 v86, v84, v85
    v_lshlrev_b32 v84, 16, v86
    v_and_b32 v85, 0xffff0000, v86
    v_add_f32 v84, v84, v48
    v_add_f32 v85, v85, v49
    v_cvt_pk_bf16_f32 v63, v84, v85
    v_mul_f32 v84, v82, v32
    v_mul_f32 v85, v83, v33
    v_cvt_pk_bf16_f32 v86, v84, v85
    v_lshlrev_b32 v84, 16, v86
    v_and_b32 v85, 0xffff0000, v86
    v_add_f32 v84, v84, v50
    v_add_f32 v85, v85, v51
    v_cvt_pk_bf16_f32 v64, v84, v85
    v_add_u32 v84, 150016, v2
    s_cmp_eq_u32 s14, 2
    s_cbranch_scc1 L_mod_ret
    ds_write_b32 v84, v56 offset:0
    ds_write_b32 v84, v57 offset:4
    ds_write_b32 v84, v58 offset:8
    ds_write_b32 v84, v59 offset:12
    ds_write_b32 v84, v60 offset:16
    ds_write_b32 v84, v61 offset:20
    ds_write_b32 v84, v62 offset:24
    ds_write_b32 v84, v63 offset:28
    ds_write_b32 v84, v64 offset:32
L_mod_ret:
    s_setpc_b64 s[62:63]
SUB_GEMV:
    v_lshrrev_b32 v200, 4, v1
    v_bfe_u32 v201, v1, 2, 2
    v_and_b32 v202, 1, v200
    v_xor_b32 v202, v202, v201
    v_lshlrev_b32 v202, 1, v202
    v_lshlrev_b32 v200, 3, v200
    v_add_u32 v200, v200, v201
    v_lshlrev_b32 v200, 7, v200
    s_lshl_b32 s64, s12, 1
    v_bfe_u32 v201, v1, 1, 1
    v_add_u32 v201, s64, v201
    v_xor_b32 v201, v201, v202
    v_lshlrev_b32 v201, 4, v201
    v_add_u32 v200, v200, v201
    v_and_b32 v201, 1, v1
    v_lshlrev_b32 v201, 3, v201
    v_add_u32 v200, v200, v201
    v_add_u32 v200, 73728, v200
    v_add_u32 v201, 0x8000, v200
    v_add_u32 v202, s81, v5
    v_bfe_u32 v203, v1, 4, 1
    v_mul_lo_u32 v203, s83, v203
    v_bfe_u32 v208, v1, 1, 3
    v_lshlrev_b32 v208, 3, v208
    v_add_u32 v203, v203, v208
    s_lshl_b32 s64, s12, 6
    s_add_u32 s82, s82, s64
    v_bfe_u32 v208, v1, 4, 1
    v_cmp_eq_u32 s[58:59], 1, v208
    ds_add_u32 v7, v8 offset:0
    s_add_u32 s13, s13, 256
    s_mov_b32 s68, 524288
L_spin_27:
    ds_read_b32 v9, v7 offset:0
    s_waitcnt lgkmcnt(0)
    v_readfirstlane_b32 s69, v9
    s_nop 0
    s_cmp_ge_u32 s69, s13
    s_cbranch_scc1 L_spind_28
    s_sub_u32 s68, s68, 1
    s_cbranch_scc1 L_abort
    s_branch L_spin_27
L_spind_28:
    ds_read_b32 v208, v7 offset:52
    s_waitcnt lgkmcnt(0)
    v_readfirstlane_b32 s79, v208
    ds_read_b64_tr_b16 v[128:129], v200 offset:0
    ds_read_b64_tr_b16 v[130:131], v200 offset:512
    ds_read_b128 v[56:59], v202 offset:0
    ds_read_b64_tr_b16 v[132:133], v200 offset:4096
    ds_read_b64_tr_b16 v[134:135], v200 offset:4608
    ds_read_b128 v[60:63], v202 offset:64
    ds_read_b64_tr_b16 v[136:137], v200 offset:8192
    ds_read_b64_tr_b16 v[138:139], v200 offset:8704
    ds_read_b128 v[64:67], v202 offset:128
    ds_read_b64_tr_b16 v[140:141], v200 offset:12288
    ds_read_b64_tr_b16 v[142:143], v200 offset:12800
    ds_read_b128 v[68:71], v202 offset:192
    ds_read_b64_tr_b16 v[144:145], v200 offset:16384
    ds_read_b64_tr_b16 v[146:147], v200 offset:16896
    ds_read_b128 v[72:75], v202 offset:256
    s_waitcnt lgkmcnt(0)
    ds_read_b64_tr_b16 v[148:149], v200 offset:20480
    ds_read_b64_tr_b16 v[150:151], v200 offset:20992
    ds_read_b128 v[76:79], v202 offset:320
    ds_read_b64_tr_b16 v[152:153], v200 offset:24576
    ds_read_b64_tr_b16 v[154:155], v200 offset:25088
    ds_read_b128 v[80:83], v202 offset:384
    ds_read_b64_tr_b16 v[156:157], v200 offset:28672
    ds_read_b64_tr_b16 v[158:159], v200 offset:29184
    ds_read_b128 v[84:87], v202 offset:448
    ds_read_b64_tr_b16 v[160:161], v201 offset:0
    ds_read_b64_tr_b16 v[162:163], v201 offset:512
    ds_read_b128 v[88:91], v202 offset:512
    ds_read_b64_tr_b16 v[164:165], v201 offset:4096
    ds_read_b64_tr_b16 v[166:167], v201 offset:4608
    ds_read_b128 v[92:95], v202 offset:576
    v_mfma_f32_16x16x32_bf16 v[204:207], v[56:59], v[128:131], 0
    v_mfma_f32_16x16x32_bf16 v[204:207], v[60:63], v[132:135], v[204:207]
    v_mfma_f32_16x16x32_bf16 v[204:207], v[64:67], v[136:139], v[204:207]
    v_mfma_f32_16x16x32_bf16 v[204:207], v[68:71], v[140:143], v[204:207]
    v_mfma_f32_16x16x32_bf16 v[204:207], v[72:75], v[144:147], v[204:207]
    s_waitcnt lgkmcnt(0)
    ds_read_b64_tr_b16 v[168:169], v201 offset:8192
    ds_read_b64_tr_b16 v[170:171], v201 offset:8704
    ds_read_b128 v[96:99], v202 offset:640
    ds_read_b64_tr_b16 v[172:173], v201 offset:12288
    ds_read_b64_tr_b16 v[174:175], v201 offset:12800
    ds_read_b128 v[100:103], v202 offset:704
    ds_read_b64_tr_b16 v[176:177], v201 offset:16384
    ds_read_b64_tr_b16 v[178:179], v201 offset:16896
    ds_read_b128 v[104:107], v202 offset:768
    ds_read_b64_tr_b16 v[180:181], v201 offset:20480
    ds_read_b64_tr_b16 v[182:183], v201 offset:20992
    ds_read_b128 v[108:111], v202 offset:832
    v_mfma_f32_16x16x32_bf16 v[204:207], v[76:79], v[148:151], v[204:207]
    v_mfma_f32_16x16x32_bf16 v[204:207], v[80:83], v[152:155], v[204:207]
    v_mfma_f32_16x16x32_bf16 v[204:207], v[84:87], v[156:159], v[204:207]
    v_mfma_f32_16x16x32_bf16 v[204:207], v[88:91], v[160:163], v[204:207]
    v_mfma_f32_16x16x32_bf16 v[204:207], v[92:95], v[164:167], v[204:207]
    s_waitcnt lgkmcnt(0)
    ds_read_b64_tr_b16 v[184:185], v201 offset:24576
    ds_read_b64_tr_b16 v[186:187], v201 offset:25088
    ds_read_b128 v[112:115], v202 offset:896
    ds_read_b64_tr_b16 v[188:189], v201 offset:28672
    ds_read_b64_tr_b16 v[190:191], v201 offset:29184
    ds_read_b128 v[116:119], v202 offset:960
    ds_read_b64_tr_b16 v[192:193], v201 offset:32768
    ds_read_b64_tr_b16 v[194:195], v201 offset:33280
    ds_read_b128 v[120:123], v202 offset:1024
    ds_read_b64_tr_b16 v[196:197], v201 offset:36864
    ds_read_b64_tr_b16 v[198:199], v201 offset:37376
    ds_read_b128 v[124:127], v202 offset:1088
    v_mfma_f32_16x16x32_bf16 v[204:207], v[96:99], v[168:171], v[204:207]
    v_mfma_f32_16x16x32_bf16 v[204:207], v[100:103], v[172:175], v[204:207]
    v_mfma_f32_16x16x32_bf16 v[204:207], v[104:107], v[176:179], v[204:207]
    v_mfma_f32_16x16x32_bf16 v[204:207], v[108:111], v[180:183], v[204:207]
    s_waitcnt lgkmcnt(0)
    v_mfma_f32_16x16x32_bf16 v[204:207], v[112:115], v[184:187], v[204:207]
    v_mfma_f32_16x16x32_bf16 v[204:207], v[116:119], v[188:191], v[204:207]
    v_mfma_f32_16x16x32_bf16 v[204:207], v[120:123], v[192:195], v[204:207]
    v_mfma_f32_16x16x32_bf16 v[204:207], v[124:127], v[196:199], v[204:207]
    s_nop 7
    v_cndmask_b32 v204, v204, v205, s[58:59]
    s_nop 1
    v_mov_b32_dpp v205, v204 quad_perm:[1,0,3,2] row_mask:0xf bank_mask:0xf
    v_cvt_pk_bf16_f32 v204, v204, v205
    v_mov_b32 v205, s79
    s_mov_b32 exec_lo, 0x55555555
    s_mov_b32 exec_hi, 0
    buffer_store_dwordx2 v[204:205], v203, s[44:47], s82 offen sc1
    s_mov_b64 exec, -1
    s_setpc_b64 s[62:63]
L_subs_end:
    s_cmp_lg_u32 s12, 0
    s_cbranch_scc1 L_p_nw0
    s_waitcnt vmcnt(0)
    v_readfirstlane_b32 s79, v110
    s_nop 0
    s_add_u32 s79, s79, 1
    v_mov_b32 v110, s79
    ds_write_b32 v7, v110 offset:52
    s_cmp_eq_u32 s9, -1
    s_cbranch_scc1 L_p_w0x
    s_mov_b32 s64, 0xbfb8aa3b
    s_mov_b32 s65, 0xb2a57060
    v_lshlrev_b32 v120, 16, v56
    v_and_b32 v121, 0xffff0000, v56
    v_mul_f32 v122, 0xbfb8aa3b, v120
    v_fma_f32 v123, v120, s64, -v122
    v_fma_f32 v123, v120, s65, v123
    v_min_f32 v122, 0x42fc0000, v122
    v_exp_f32 v122, v122
    s_nop 0
    v_mul_f32 v124, 0x3f317218, v122
    v_fma_f32 v122, v124, v123, v122
    v_add_f32 v122, 1.0, v122
    v_rcp_f32 v123, v122
    s_nop 0
    v_mul_f32 v124, v120, v123
    v_fma_f32 v125, -v124, v122, v120
    v_fma_f32 v120, v125, v123, v124
    v_mul_f32 v122, 0xbfb8aa3b, v121
    v_fma_f32 v123, v121, s64, -v122
    v_fma_f32 v123, v121, s65, v123
    v_min_f32 v122, 0x42fc0000, v122
    v_exp_f32 v122, v122
    s_nop 0
    v_mul_f32 v124, 0x3f317218, v122
    v_fma_f32 v122, v124, v123, v122
    v_add_f32 v122, 1.0, v122
    v_rcp_f32 v123, v122
    s_nop 0
    v_mul_f32 v124, v121, v123
    v_fma_f32 v125, -v124, v122, v121
    v_fma_f32 v121, v125, v123, v124
    v_cvt_pk_bf16_f32 v56, v120, v121
    v_lshlrev_b32 v120, 16, v57
    v_and_b32 v121, 0xffff0000, v57
    v_mul_f32 v122, 0xbfb8aa3b, v120
    v_fma_f32 v123, v120, s64, -v122
    v_fma_f32 v123, v120, s65, v123
    v_min_f32 v122, 0x42fc0000, v122
    v_exp_f32 v122, v122
    s_nop 0
    v_mul_f32 v124, 0x3f317218, v122
    v_fma_f32 v122, v124, v123, v122
    v_add_f32 v122, 1.0, v122
    v_rcp_f32 v123, v122
    s_nop 0
    v_mul_f32 v124, v120, v123
    v_fma_f32 v125, -v124, v122, v120
    v_fma_f32 v120, v125, v123, v124
    v_mul_f32 v122, 0xbfb8aa3b, v121
    v_fma_f32 v123, v121, s64, -v122
    v_fma_f32 v123, v121, s65, v123
    v_min_f32 v122, 0x42fc0000, v122
    v_exp_f32 v122, v122
    s_nop 0
    v_mul_f32 v124, 0x3f317218, v122
    v_fma_f32 v122, v124, v123, v122
    v_add_f32 v122, 1.0, v122
    v_rcp_f32 v123, v122
    s_nop 0
    v_mul_f32 v124, v121, v123
    v_fma_f32 v125, -v124, v122, v121
    v_fma_f32 v121, v125, v123, v124
    v_cvt_pk_bf16_f32 v57, v120, v121
    v_lshlrev_b32 v120, 16, v58
    v_and_b32 v121, 0xffff0000, v58
    v_mul_f32 v122, 0xbfb8aa3b, v120
    v_fma_f32 v123, v120, s64, -v122
    v_fma_f32 v123, v120, s65, v123
    v_min_f32 v122, 0x42fc0000, v122
    v_exp_f32 v122, v122
    s_nop 0
    v_mul_f32 v124, 0x3f317218, v122
    v_fma_f32 v122, v124, v123, v122
    v_add_f32 v122, 1.0, v122
    v_rcp_f32 v123, v122
    s_nop 0
    v_mul_f32 v124, v120, v123
    v_fma_f32 v125, -v124, v122, v120
    v_fma_f32 v120, v125, v123, v124
    v_mul_f32 v122, 0xbfb8aa3b, v121
    v_fma_f32 v123, v121, s64, -v122
    v_fma_f32 v123, v121, s65, v123
    v_min_f32 v122, 0x42fc0000, v122
    v_exp_f32 v122, v122
    s_nop 0
    v_mul_f32 v124, 0x3f317218, v122
    v_fma_f32 v122, v124, v123, v122
    v_add_f32 v122, 1.0, v122
    v_rcp_f32 v123, v122
    s_nop 0
    v_mul_f32 v124, v121, v123
    v_fma_f32 v125, -v124, v122, v121
    v_fma_f32 v121, v125, v123, v124
    v_cvt_pk_bf16_f32 v58, v120, v121
    v_lshlrev_b32 v120, 16, v59
    v_and_b32 v121, 0xffff0000, v59
    v_mul_f32 v122, 0xbfb8aa3b, v120
    v_fma_f32 v123, v120, s64, -v122
    v_fma_f32 v123, v120, s65, v123
    v_min_f32 v122, 0x42fc0000, v122
    v_exp_f32 v122, v122
    s_nop 0
    v_mul_f32 v124, 0x3f317218, v122
    v_fma_f32 v122, v124, v123, v122
    v_add_f32 v122, 1.0, v122
    v_rcp_f32 v123, v122
    s_nop 0
    v_mul_f32 v124, v120, v123
    v_fma_f32 v125, -v124, v122, v120
    v_fma_f32 v120, v125, v123, v124
    v_mul_f32 v122, 0xbfb8aa3b, v121
    v_fma_f32 v123, v121, s64, -v122
    v_fma_f32 v123, v121, s65, v123
    v_min_f32 v122, 0x42fc0000, v122
    v_exp_f32 v122, v122
    s_nop 0
    v_mul_f32 v124, 0x3f317218, v122
    v_fma_f32 v122, v124, v123, v122
    v_add_f32 v122, 1.0, v122
    v_rcp_f32 v123, v122
    s_nop 0
    v_mul_f32 v124, v121, v123
    v_fma_f32 v125, -v124, v122, v121
    v_fma_f32 v121, v125, v123, v124
    v_cvt_pk_bf16_f32 v59, v120, v121
    v_lshlrev_b32 v120, 16, v60
    v_and_b32 v121, 0xffff0000, v60
    v_mul_f32 v122, 0xbfb8aa3b, v120
    v_fma_f32 v123, v120, s64, -v122
    v_fma_f32 v123, v120, s65, v123
    v_min_f32 v122, 0x42fc0000, v122
    v_exp_f32 v122, v122
    s_nop 0
    v_mul_f32 v124, 0x3f317218, v122
    v_fma_f32 v122, v124, v123, v122
    v_add_f32 v122, 1.0, v122
    v_rcp_f32 v123, v122
    s_nop 0
    v_mul_f32 v124, v120, v123
    v_fma_f32 v125, -v124, v122, v120
    v_fma_f32 v120, v125, v123, v124
    v_mul_f32 v122, 0xbfb8aa3b, v121
    v_fma_f32 v123, v121, s64, -v122
    v_fma_f32 v123, v121, s65, v123
    v_min_f32 v122, 0x42fc0000, v122
    v_exp_f32 v122, v122
    s_nop 0
    v_mul_f32 v124, 0x3f317218, v122
    v_fma_f32 v122, v124, v123, v122
    v_add_f32 v122, 1.0, v122
    v_rcp_f32 v123, v122
    s_nop 0
    v_mul_f32 v124, v121, v123
    v_fma_f32 v125, -v124, v122, v121
    v_fma_f32 v121, v125, v123, v124
    v_cvt_pk_bf16_f32 v60, v120, v121
    v_lshlrev_b32 v120, 16, v61
    v_and_b32 v121, 0xffff0000, v61
    v_mul_f32 v122, 0xbfb8aa3b, v120
    v_fma_f32 v123, v120, s64, -v122
    v_fma_f32 v123, v120, s65, v123
    v_min_f32 v122, 0x42fc0000, v122
    v_exp_f32 v122, v122
    s_nop 0
    v_mul_f32 v124, 0x3f317218, v122
    v_fma_f32 v122, v124, v123, v122
    v_add_f32 v122, 1.0, v122
    v_rcp_f32 v123, v122
    s_nop 0
    v_mul_f32 v124, v120, v123
    v_fma_f32 v125, -v124, v122, v120
    v_fma_f32 v120, v125, v123, v124
    v_mul_f32 v122, 0xbfb8aa3b, v121
    v_fma_f32 v123, v121, s64, -v122
    v_fma_f32 v123, v121, s65, v123
    v_min_f32 v122, 0x42fc0000, v122
    v_exp_f32 v122, v122
    s_nop 0
    v_mul_f32 v124, 0x3f317218, v122
    v_fma_f32 v122, v124, v123, v122
    v_add_f32 v122, 1.0, v122
    v_rcp_f32 v123, v122
    s_nop 0
    v_mul_f32 v124, v121, v123
    v_fma_f32 v125, -v124, v122, v121
    v_fma_f32 v121, v125, v123, v124
    v_cvt_pk_bf16_f32 v61, v120, v121
    v_lshlrev_b32 v120, 16, v62
    v_and_b32 v121, 0xffff0000, v62
    v_mul_f32 v122, 0xbfb8aa3b, v120
    v_fma_f32 v123, v120, s64, -v122
    v_fma_f32 v123, v120, s65, v123
    v_min_f32 v122, 0x42fc0000, v122
    v_exp_f32 v122, v122
    s_nop 0
    v_mul_f32 v124, 0x3f317218, v122
    v_fma_f32 v122, v124, v123, v122
    v_add_f32 v122, 1.0, v122
    v_rcp_f32 v123, v122
    s_nop 0
    v_mul_f32 v124, v120, v123
    v_fma_f32 v125, -v124, v122, v120
    v_fma_f32 v120, v125, v123, v124
    v_mul_f32 v122, 0xbfb8aa3b, v121
    v_fma_f32 v123, v121, s64, -v122
    v_fma_f32 v123, v121, s65, v123
    v_min_f32 v122, 0x42fc0000, v122
    v_exp_f32 v122, v122
    s_nop 0
    v_mul_f32 v124, 0x3f317218, v122
    v_fma_f32 v122, v124, v123, v122
    v_add_f32 v122, 1.0, v122
    v_rcp_f32 v123, v122
    s_nop 0
    v_mul_f32 v124, v121, v123
    v_fma_f32 v125, -v124, v122, v121
    v_fma_f32 v121, v125, v123, v124
    v_cvt_pk_bf16_f32 v62, v120, v121
    v_lshlrev_b32 v120, 16, v63
    v_and_b32 v121, 0xffff0000, v63
    v_mul_f32 v122, 0xbfb8aa3b, v120
    v_fma_f32 v123, v120, s64, -v122
    v_fma_f32 v123, v120, s65, v123
    v_min_f32 v122, 0x42fc0000, v122
    v_exp_f32 v122, v122
    s_nop 0
    v_mul_f32 v124, 0x3f317218, v122
    v_fma_f32 v122, v124, v123, v122
    v_add_f32 v122, 1.0, v122
    v_rcp_f32 v123, v122
    s_nop 0
    v_mul_f32 v124, v120, v123
    v_fma_f32 v125, -v124, v122, v120
    v_fma_f32 v120, v125, v123, v124
    v_mul_f32 v122, 0xbfb8aa3b, v121
    v_fma_f32 v123, v121, s64, -v122
    v_fma_f32 v123, v121, s65, v123
    v_min_f32 v122, 0x42fc0000, v122
    v_exp_f32 v122, v122
    s_nop 0
    v_mul_f32 v124, 0x3f317218, v122
    v_fma_f32 v122, v124, v123, v122
    v_add_f32 v122, 1.0, v122
    v_rcp_f32 v123, v122
    s_nop 0
    v_mul_f32 v124, v121, v123
    v_fma_f32 v125, -v124, v122, v121
    v_fma_f32 v121, v125, v123, v124
    v_cvt_pk_bf16_f32 v63, v120, v121
    v_lshlrev_b32 v120, 16, v64
    v_and_b32 v121, 0xffff0000, v64
    v_mul_f32 v122, 0xbfb8aa3b, v120
    v_fma_f32 v123, v120, s64, -v122
    v_fma_f32 v123, v120, s65, v123
    v_min_f32 v122, 0x42fc0000, v122
    v_exp_f32 v122, v122
    s_nop 0
    v_mul_f32 v124, 0x3f317218, v122
    v_fma_f32 v122, v124, v123, v122
    v_add_f32 v122, 1.0, v122
    v_rcp_f32 v123, v122
    s_nop 0
    v_mul_f32 v124, v120, v123
    v_fma_f32 v125, -v124, v122, v120
    v_fma_f32 v120, v125, v123, v124
    v_mul_f32 v122, 0xbfb8aa3b, v121
    v_fma_f32 v123, v121, s64, -v122
    v_fma_f32 v123, v121, s65, v123
    v_min_f32 v122, 0x42fc0000, v122
    v_exp_f32 v122, v122
    s_nop 0
    v_mul_f32 v124, 0x3f317218, v122
    v_fma_f32 v122, v124, v123, v122
    v_add_f32 v122, 1.0, v122
    v_rcp_f32 v123, v122
    s_nop 0
    v_mul_f32 v124, v121, v123
    v_fma_f32 v125, -v124, v122, v121
    v_fma_f32 v121, v125, v123, v124
    v_cvt_pk_bf16_f32 v64, v120, v121
    v_add_u32 v120, 147712, v2
    ds_write_b32 v120, v56 offset:0
    ds_write_b32 v120, v57 offset:4
    ds_write_b32 v120, v58 offset:8
    ds_write_b32 v120, v59 offset:12
    ds_write_b32 v120, v60 offset:16
    ds_write_b32 v120, v61 offset:20
    ds_write_b32 v120, v62 offset:24
    ds_write_b32 v120, v63 offset:28
    ds_write_b32 v120, v64 offset:32
    s_branch L_p_nw0
L_p_w0x:
    s_cmp_eq_u32 s8, -1
    s_cbranch_scc1 L_p_nw0
    s_call_b64 s[62:63], SUB_LN
L_p_nw0:
    s_cmp_lg_u32 s12, 3
    s_cbranch_scc1 L_p_nw3
    v_mov_b32 v56, -1
    v_mov_b32 v57, -1
    v_mov_b32 v58, -1
    v_mov_b32 v59, -1
    v_lshlrev_b32 v60, 4, v1
    s_lshl_b32 s64, s4, 14
    s_lshl_b32 s65, s5, 10
    s_add_u32 s64, s64, s65
    s_add_u32 s64, s64, 65536
    buffer_store_dwordx4 v[56:59], v60, s[44:47], s64 offen sc1
    s_add_u32 s64, s64, 262144
    buffer_store_dwordx4 v[56:59], v60, s[44:47], s64 offen sc1
    v_bfe_u32 v60, v1, 2, 1
    v_lshlrev_b32 v60, 13, v60
    v_bfe_u32 v61, v1, 1, 1
    v_lshlrev_b32 v61, 8, v61
    v_add_u32 v60, v60, v61
    v_and_b32 v61, 1, v1
    v_lshlrev_b32 v61, 3, v61
    v_add_u32 v60, v60, v61
    s_lshl_b32 s64, s4, 9
    s_lshl_b32 s65, s5, 4
    s_add_u32 s64, s64, s65
    s_add_u32 s64, s64, 32768
    s_mov_b64 exec, 0xff
    buffer_store_dwordx2 v[56:57], v60, s[44:47], s64 offen sc1
    s_mov_b64 exec, -1
    s_cmp_eq_u32 s11, -1
    s_cbranch_scc1 L_i_nox1
    s_and_b32 s64, s11, 1
    s_mul_i32 s64, s64, 1152
    s_lshr_b32 s65, s11, 1
    s_lshl_b32 s65, s65, 6
    s_add_u32 s64, s64, s65
    s_add_u32 s64, s64, 1114112
    v_and_b32 v60, 3, v1
    v_lshlrev_b32 v60, 4, v60
    v_bfe_u32 v61, v1, 2, 2
    v_mul_u32_u24 v61, 2304, v61
    v_add_u32 v60, v60, v61
    s_mov_b64 exec, 0xffff
    buffer_store_dwordx4 v[56:59], v60, s[44:47], s64 offen sc1
    s_mov_b64 exec, -1
L_i_nox1:
    s_mov_b32 s65, 14336
    s_mov_b32 s66, 589824
    s_cmp_eq_u32 s6, 1
    s_cselect_b32 s65, 18432, s65
    s_cselect_b32 s66, 1179648, s66
    s_lshl_b32 s64, s7, 7
    s_add_u32 s64, s64, s66
    v_lshrrev_b32 v60, 3, v1
    v_and_b32 v61, 7, v1
    v_lshlrev_b32 v61, 4, v61
    v_add_u32 v62, 0, v60
    v_min_u32 v62, 35, v62
    v_mul_lo_u32 v62, s65, v62
    v_add_u32 v62, v62, v61
    buffer_store_dwordx4 v[56:59], v62, s[44:47], s64 offen sc1
    v_add_u32 v62, 8, v60
    v_min_u32 v62, 35, v62
    v_mul_lo_u32 v62, s65, v62
    v_add_u32 v62, v62, v61
    buffer_store_dwordx4 v[56:59], v62, s[44:47], s64 offen sc1
    v_add_u32 v62, 16, v60
    v_min_u32 v62, 35, v62
    v_mul_lo_u32 v62, s65, v62
    v_add_u32 v62, v62, v61
    buffer_store_dwordx4 v[56:59], v62, s[44:47], s64 offen sc1
    v_add_u32 v62, 24, v60
    v_min_u32 v62, 35, v62
    v_mul_lo_u32 v62, s65, v62
    v_add_u32 v62, v62, v61
    buffer_store_dwordx4 v[56:59], v62, s[44:47], s64 offen sc1
    v_add_u32 v62, 32, v60
    v_min_u32 v62, 35, v62
    v_mul_lo_u32 v62, s65, v62
    v_add_u32 v62, v62, v61
    buffer_store_dwordx4 v[56:59], v62, s[44:47], s64 offen sc1
L_p_nw3:
    s_cmp_eq_u32 s12, 0
    s_cbranch_scc1 L_p_nrel
    s_cmp_eq_u32 s12, 3
    s_cbranch_scc1 L_p_nrel
    s_waitcnt vmcnt(17)
    ds_add_u32 v7, v8 offset:40
    s_waitcnt vmcnt(0)
    ds_add_u32 v7, v8 offset:64
L_p_nrel:
    s_cmp_eq_u32 s9, -1
    s_cbranch_scc1 L_p_now1
    s_mov_b32 s81, 147712
    s_add_u32 s66, s9, 0
    s_mul_i32 s82, s66, 7282
    s_lshr_b32 s82, s82, 16
    s_mul_i32 s65, s82, 9
    s_sub_u32 s65, s66, s65
    s_mul_i32 s82, s82, 4608
    s_lshl_b32 s65, s65, 8
    s_add_u32 s82, s82, s65
    s_mov_b32 s83, 2304
    s_call_b64 s[62:63], SUB_GEMV
    s_cmp_eq_u32 s61, 0
    s_cbranch_scc1 L_p_now1
    ds_add_u32 v7, v8 offset:0
    s_add_u32 s13, s13, 256
    s_mov_b32 s68, 524288
L_spin_29:
    ds_read_b32 v9, v7 offset:0
    s_waitcnt lgkmcnt(0)
    v_readfirstlane_b32 s69, v9
    s_nop 0
    s_cmp_ge_u32 s69, s13
    s_cbranch_scc1 L_spind_30
    s_sub_u32 s68, s68, 1
    s_cbranch_scc1 L_abort
    s_branch L_spin_29
L_spind_30:
    s_cmp_eq_u32 s12, 0
    s_cbranch_scc1 L_p1b_go
    s_cmp_eq_u32 s12, 3
    s_cbranch_scc1 L_p1b_go
    s_mov_b32 s52, s36
    s_mov_b32 s53, s37
    s_mov_b32 s54, 3981312
    s_mov_b32 s55, 0x20000
    v_lshrrev_b32 v9, 3, v1
    v_and_b32 v15, 3, v9
    v_lshlrev_b32 v15, 1, v15
    v_and_b32 v56, 7, v1
    v_xor_b32 v15, v15, v56
    v_xor_b32 v56, 2, v15
    v_mul_u32_u24 v9, 6912, v9
    v_lshlrev_b32 v15, 4, v15
    v_lshlrev_b32 v56, 4, v56
    v_add_u32 v56, v9, v56
    v_add_u32 v9, v9, v15
    s_sub_u32 s67, s12, 1
    s_mul_i32 s64, s67, 1990656
    s_add_u32 s65, s9, 30
    s_lshl_b32 s65, s65, 7
    s_add_u32 s64, s64, s65
    s_mul_i32 s65, s67, 36864
    s_add_u32 s65, s65, 73728
    s_mov_b32 s66, 18
L_cdma_31:
    s_mov_b32 m0, s65
    s_add_u32 s65, s65, 1024
    s_waitcnt vmcnt(35)
    buffer_load_dwordx4 v9, s[52:55], s64 offen nt lds
    s_add_u32 s64, s64, 55296
    s_mov_b32 m0, s65
    s_add_u32 s65, s65, 1024
    s_waitcnt vmcnt(35)
    buffer_load_dwordx4 v56, s[52:55], s64 offen nt lds
    s_add_u32 s64, s64, 55296
    s_sub_u32 s66, s66, 1
    s_cmp_lg_u32 s66, 0
    s_cbranch_scc1 L_cdma_31
    s_waitcnt vmcnt(0)
L_p1b_go:
    s_mov_b32 s81, 147712
    s_add_u32 s66, s9, 30
    s_mul_i32 s82, s66, 7282
    s_lshr_b32 s82, s82, 16
    s_mul_i32 s65, s82, 9
    s_sub_u32 s65, s66, s65
    s_mul_i32 s82, s82, 4608
    s_lshl_b32 s65, s65, 8
    s_add_u32 s82, s82, s65
    s_mov_b32 s83, 2304
    s_call_b64 s[62:63], SUB_GEMV
L_p_now1:
    s_cmp_eq_u32 s8, -1
    s_cbranch_scc1 L_p_noq
    s_cmp_lg_u32 s12, 0
    s_cbranch_scc1 L_p2_go
    s_mov_b32 s68, 524288
L_spin_32:
    ds_read_b32 v9, v7 offset:64
    s_waitcnt lgkmcnt(0)
    v_readfirstlane_b32 s69, v9
    s_nop 0
    s_cmp_ge_u32 s69, 128
    s_cbranch_scc1 L_spind_33
    s_sub_u32 s68, s68, 1
    s_cbranch_scc1 L_abort
    s_sleep 1
    s_branch L_spin_32
L_spind_33:
    s_sleep 80
    s_mov_b32 s80, 0
    s_mov_b32 s81, 4608
    s_call_b64 s[62:63], SUB_PREP
    s_call_b64 s[62:63], SUB_MOD
L_p2_go:
    s_mov_b32 s81, 150016
    s_lshl_b32 s82, s8, 8
    s_add_u32 s82, s82, 1867776
    s_mov_b32 s83, 16384
    s_call_b64 s[62:63], SUB_GEMV
L_p_noq:
    s_cmp_lg_u32 s12, 0
    s_cbranch_scc0 L_p3_w0
    ds_add_u32 v7, v8 offset:60
    s_branch L_p3_done
L_p3_w0:
    s_mov_b32 s68, 524288
L_spin_34:
    ds_read_b32 v9, v7 offset:48
    s_waitcnt lgkmcnt(0)
    v_readfirstlane_b32 s69, v9
    s_nop 0
    s_cmp_ge_u32 s69, 256
    s_cbranch_scc1 L_spind_35
    s_sub_u32 s68, s68, 1
    s_cbranch_scc1 L_abort
    s_sleep 2
    s_branch L_spin_34
L_spind_35:
    v_lshrrev_b32 v60, 5, v1
    v_lshlrev_b32 v60, 14, v60
    v_lshlrev_b32 v61, 5, v13
    v_add_u32 v60, v60, v61
    s_lshl_b32 s64, s4, 10
    s_add_u32 s64, s64, 1867776
    s_mov_b32 s68, 524288
    s_cmp_lg_u32 s14, 0
    s_cbranch_scc1 L_polltdq_37
L_polltq_36:
    buffer_load_dwordx4 v[56:59], v60, s[44:47], s64 offen sc1
    buffer_load_dwordx4 v[62:65], v60, s[44:47], s64 offen offset:16 sc1
    s_waitcnt vmcnt(0)
    v_xor_b32 v9, s79, v57
    v_xor_b32 v59, s79, v59
    v_xor_b32 v63, s79, v63
    v_xor_b32 v65, s79, v65
    v_or3_b32 v9, v9, v59, v63
    v_or_b32 v9, v9, v65
    v_cmp_ne_u32 vcc, 0, v9
    s_cbranch_vccz L_polltdq_37
    s_sub_u32 s68, s68, 1
    s_cbranch_scc1 L_abort
    s_sleep 8
    s_branch L_polltq_36
L_polltdq_37:
    v_mov_b32 v57, v58
    v_mov_b32 v58, v62
    v_mov_b32 v59, v64
    v_lshrrev_b32 v60, 5, v1
    v_lshlrev_b32 v60, 9, v60
    v_lshlrev_b32 v61, 4, v13
    v_add_u32 v60, v60, v61
    v_add_u32 v60, 152320, v60
    ds_write_b128 v60, v[56:59]
    s_mov_b32 s68, 524288
L_spin_38:
    ds_read_b32 v9, v7 offset:60
    s_waitcnt lgkmcnt(0)
    v_readfirstlane_b32 s69, v9
    s_nop 0
    s_cmp_ge_u32 s69, 192
    s_cbranch_scc1 L_spind_39
    s_sub_u32 s68, s68, 1
    s_cbranch_scc1 L_abort
    s_branch L_spin_38
L_spind_39:
    ds_add_u32 v7, v8 offset:4
L_p3_done:
    s_cmp_lg_u32 s12, 3
    s_cbranch_scc1 L_b_nw3
    s_waitcnt vmcnt(0)
    s_mov_b32 s52, s40
    s_mov_b32 s53, s41
    s_mov_b32 s54, 256
    s_mov_b32 s55, 0x20000
    s_and_b32 s64, s2, 3
    s_lshl_b32 s64, s64, 6
    v_mov_b32 v60, 4
    s_mov_b64 exec, 1
    buffer_atomic_add v8, v60, s[52:55], s64 offen
    s_mov_b64 exec, -1
L_b_nw3:
    s_mov_b32 s68, 524288
L_spin_40:
    ds_read_b32 v9, v7 offset:44
    s_waitcnt lgkmcnt(0)
    v_readfirstlane_b32 s69, v9
    s_nop 0
    s_cmp_ge_u32 s69, 256
    s_cbranch_scc1 L_spind_41
    s_sub_u32 s68, s68, 1
    s_cbranch_scc1 L_abort
    s_sleep 4
    s_branch L_spin_40
L_spind_41:
    s_cmp_lg_u32 s12, 3
    s_cbranch_scc1 L_b2_nw3
    s_mov_b32 s52, s40
    s_mov_b32 s53, s41
    s_mov_b32 s54, 256
    s_mov_b32 s55, 0x20000
    v_and_b32 v56, 3, v1
    v_lshlrev_b32 v56, 6, v56
    s_mov_b32 s68, 524288
L_pinit_42:
    buffer_load_dword v57, v56, s[52:55], 0 offen offset:4 sc1
    s_waitcnt vmcnt(0)
    v_cmp_gt_u32 vcc, 64, v57
    s_cbranch_vccz L_pinitd_43
    s_sub_u32 s68, s68, 1
    s_cbranch_scc1 L_abort
    s_sleep 16
    s_branch L_pinit_42
L_pinitd_43:
    ds_add_u32 v7, v8 offset:36
L_b2_nw3:
    ds_read_b32 v56, v7 offset:52
    s_waitcnt lgkmcnt(0)
    v_readfirstlane_b32 s79, v56
    s_cmp_eq_u32 s6, 0
    s_cbranch_scc1 L_c8_nonffn0
    v_min_u32 v60, 47, v1
    v_mul_u32_u24 v61, 12, v60
    s_and_b32 s64, s12, 1
    s_mul_i32 s64, s64, 1152
    s_lshr_b32 s65, s12, 1
    s_mul_i32 s66, s65, 576
    s_add_u32 s67, s64, s66
    v_add_u32 v28, s67, v61
    s_sub_u32 s66, 576, s66
    s_add_u32 s66, s64, s66
    v_add_u32 v29, s66, v61
    v_lshlrev_b32 v60, 1, v28
    s_mov_b32 s65, 13824
    s_mov_b32 s66, 18432
    s_mov_b32 s68, 524288
    s_cmp_lg_u32 s14, 0
    s_cbranch_scc1 L_polltdsb_45
L_polltsb_44:
    buffer_load_dwordx4 v[64:67], v60, s[44:47], s65 offen sc1
    buffer_load_dwordx2 v[68:69], v60, s[44:47], s65 offen offset:16 sc1
    buffer_load_dwordx4 v[70:73], v60, s[44:47], s66 offen sc1
    buffer_load_dwordx2 v[74:75], v60, s[44:47], s66 offen offset:16 sc1
    s_waitcnt vmcnt(0)
    v_xor_b32 v9, s79, v65
    v_xor_b32 v67, s79, v67
    v_xor_b32 v69, s79, v69
    v_xor_b32 v71, s79, v71
    v_xor_b32 v73, s79, v73
    v_xor_b32 v75, s79, v75
    v_or3_b32 v9, v9, v67, v69
    v_or3_b32 v9, v9, v71, v73
    v_or_b32 v9, v9, v75
    v_cmp_ne_u32 vcc, 0, v9
    s_cbranch_vccz L_polltdsb_45
    s_sub_u32 s68, s68, 1
    s_cbranch_scc1 L_abort
    s_sleep 16
    s_branch L_polltsb_44
L_polltdsb_45:
    v_lshlrev_b32 v22, 16, v64
    v_and_b32 v23, 0xffff0000, v64
    v_lshlrev_b32 v16, 16, v70
    v_and_b32 v17, 0xffff0000, v70
    v_add_f32 v16, 1.0, v16
    v_add_f32 v17, 1.0, v17
    v_cvt_pk_bf16_f32 v76, v16, v17
    v_lshlrev_b32 v16, 16, v76
    v_and_b32 v17, 0xffff0000, v76
    v_lshlrev_b32 v24, 16, v66
    v_and_b32 v25, 0xffff0000, v66
    v_lshlrev_b32 v18, 16, v72
    v_and_b32 v19, 0xffff0000, v72
    v_add_f32 v18, 1.0, v18
    v_add_f32 v19, 1.0, v19
    v_cvt_pk_bf16_f32 v76, v18, v19
    v_lshlrev_b32 v18, 16, v76
    v_and_b32 v19, 0xffff0000, v76
    v_lshlrev_b32 v26, 16, v68
    v_and_b32 v27, 0xffff0000, v68
    v_lshlrev_b32 v20, 16, v74
    v_and_b32 v21, 0xffff0000, v74
    v_add_f32 v20, 1.0, v20
    v_add_f32 v21, 1.0, v21
    v_cvt_pk_bf16_f32 v76, v20, v21
    v_lshlrev_b32 v20, 16, v76
    v_and_b32 v21, 0xffff0000, v76
    s_branch L_p_done
L_c8_nonffn0:
    s_cmp_lg_u32 s12, 0
    s_cbranch_scc1 L_p_done
L_c8_nonffn:
    s_cmp_eq_u32 s11, -1
    s_cbranch_scc1 L_p_done
    s_and_b32 s64, s11, 1
    s_mul_i32 s64, s64, 1152
    s_lshr_b32 s65, s11, 1
    s_lshl_b32 s65, s65, 6
    s_add_u32 s64, s64, s65
    v_lshrrev_b32 v60, 1, v13
    v_lshlrev_b32 v61, 3, v60
    v_lshlrev_b32 v60, 2, v60
    s_lshl_b32 s65, s64, 1
    s_add_u32 s66, s65, 23040
    s_add_u32 s65, s65, 9216
    s_mov_b32 s52, s16
    s_mov_b32 s53, s17
    s_mov_b32 s54, 2304
    s_mov_b32 s55, 0x20000
    s_mov_b32 s68, 524288
    s_cmp_lg_u32 s14, 0
    s_cbranch_scc1 L_polltdg_47
L_polltg_46:
    buffer_load_dwordx2 v[56:57], v61, s[44:47], s65 offen sc1
    buffer_load_dwordx2 v[64:65], v61, s[44:47], s66 offen sc1
    buffer_load_dword v58, v60, s[52:55], s64 offen
    s_waitcnt vmcnt(0)
    v_xor_b32 v9, s79, v57
    v_xor_b32 v65, s79, v65
    v_or_b32 v9, v9, v65
    v_cmp_ne_u32 vcc, 0, v9
    s_cbranch_vccz L_polltdg_47
    s_sub_u32 s68, s68, 1
    s_cbranch_scc1 L_abort
    s_sleep 16
    s_branch L_polltg_46
L_polltdg_47:
    v_mov_b32 v57, v64
    v_and_b32 v61, 1, v13
    v_cmp_eq_u32 vcc, 1, v61
    v_lshlrev_b32 v62, 16, v56
    v_and_b32 v63, 0xffff0000, v56
    v_cndmask_b32 v52, v62, v63, vcc
    v_lshlrev_b32 v62, 16, v57
    v_and_b32 v63, 0xffff0000, v57
    v_cndmask_b32 v53, v62, v63, vcc
    v_lshlrev_b32 v62, 16, v58
    v_and_b32 v63, 0xffff0000, v58
    v_cndmask_b32 v54, v62, v63, vcc
L_p_done:
    s_mov_b32 s68, 524288
L_spin_48:
    ds_read_b32 v9, v7 offset:36
    s_waitcnt lgkmcnt(0)
    v_readfirstlane_b32 s69, v9
    s_nop 0
    s_cmp_ge_u32 s69, 64
    s_cbranch_scc1 L_spind_49
    s_sub_u32 s68, s68, 1
    s_cbranch_scc1 L_abort
    s_sleep 4
    s_branch L_spin_48
L_spind_49:
    s_mov_b32 s15, 0
    v_mov_b32 v15, 147456
L_mid:
    s_mov_b32 s68, 524288
L_spin_50:
    ds_read_b32 v9, v15 offset:8
    s_waitcnt lgkmcnt(0)
    v_readfirstlane_b32 s69, v9
    s_nop 0
    s_cmp_ge_u32 s69, 256
    s_cbranch_scc1 L_spind_51
    s_sub_u32 s68, s68, 1
    s_cbranch_scc1 L_abort
    s_sleep 4
    s_branch L_spin_50
L_spind_51:
    s_and_b32 s80, s12, 1
    s_lshr_b32 s81, s12, 1
    s_lshl_b32 s82, s15, 13
    s_lshl_b32 s66, s80, 12
    s_lshl_b32 s67, s81, 11
    s_add_u32 s66, s66, s67
    s_add_u32 s66, s66, s82
    s_add_u32 s66, s66, 110592
    v_lshlrev_b32 v56, 5, v1
    v_add_u32 v56, s66, v56
    ds_read_b128 v[60:63], v56
    ds_read_b128 v[64:67], v56 offset:16
    s_waitcnt lgkmcnt(0)
    s_mov_b32 s66, 1035273459
    v_cvt_pk_bf16_f32 v70, v60, v61
    v_lshlrev_b32 v60, 16, v70
    v_and_b32 v61, 0xffff0000, v70
    v_mul_f32 v60, s66, v60
    v_mul_f32 v61, s66, v61
    v_cvt_pk_bf16_f32 v70, v60, v61
    v_lshlrev_b32 v60, 16, v70
    v_and_b32 v61, 0xffff0000, v70
    v_cvt_pk_bf16_f32 v70, v62, v63
    v_lshlrev_b32 v62, 16, v70
    v_and_b32 v63, 0xffff0000, v70
    v_mul_f32 v62, s66, v62
    v_mul_f32 v63, s66, v63
    v_cvt_pk_bf16_f32 v70, v62, v63
    v_lshlrev_b32 v62, 16, v70
    v_and_b32 v63, 0xffff0000, v70
    v_cvt_pk_bf16_f32 v70, v64, v65
    v_lshlrev_b32 v64, 16, v70
    v_and_b32 v65, 0xffff0000, v70
    v_mul_f32 v64, s66, v64
    v_mul_f32 v65, s66, v65
    v_cvt_pk_bf16_f32 v70, v64, v65
    v_lshlrev_b32 v64, 16, v70
    v_and_b32 v65, 0xffff0000, v70
    v_cvt_pk_bf16_f32 v70, v66, v67
    v_lshlrev_b32 v66, 16, v70
    v_and_b32 v67, 0xffff0000, v70
    v_mul_f32 v66, s66, v66
    v_mul_f32 v67, s66, v67
    v_cvt_pk_bf16_f32 v70, v66, v67
    v_lshlrev_b32 v66, 16, v70
    v_and_b32 v67, 0xffff0000, v70
    v_max3_f32 v70, v60, v61, v62
    v_max3_f32 v70, v70, v63, v64
    v_max3_f32 v70, v70, v65, v66
    v_max_f32 v70, v70, v67
    s_nop 1
    v_max_f32_dpp v70, v70, v70 row_ror:8 row_mask:0xf bank_mask:0xf
    s_nop 1
    v_max_f32_dpp v70, v70, v70 row_ror:4 row_mask:0xf bank_mask:0xf
    s_nop 1
    v_max_f32_dpp v70, v70, v70 row_ror:2 row_mask:0xf bank_mask:0xf
    s_nop 1
    v_max_f32_dpp v70, v70, v70 row_ror:1 row_mask:0xf bank_mask:0xf
    v_mov_b32 v71, v70
    s_nop 1
    v_permlane16_swap_b32 v70, v71
    v_max_f32 v70, v70, v71
    v_mov_b32 v71, v70
    s_nop 1
    v_permlane32_swap_b32 v70, v71
    v_max_f32 v70, v70, v71
    s_mov_b32 s66, 1069066811
    v_mov_b32 v72, 0
    v_sub_f32 v71, v60, v70
    v_mul_f32 v71, s66, v71
    v_exp_f32 v71, v71
    s_nop 0
    v_add_f32 v72, v72, v71
    v_sub_f32 v71, v61, v70
    v_mul_f32 v71, s66, v71
    v_exp_f32 v71, v71
    s_nop 0
    v_add_f32 v72, v72, v71
    v_sub_f32 v71, v62, v70
    v_mul_f32 v71, s66, v71
    v_exp_f32 v71, v71
    s_nop 0
    v_add_f32 v72, v72, v71
    v_sub_f32 v71, v63, v70
    v_mul_f32 v71, s66, v71
    v_exp_f32 v71, v71
    s_nop 0
    v_add_f32 v72, v72, v71
    v_sub_f32 v71, v64, v70
    v_mul_f32 v71, s66, v71
    v_exp_f32 v71, v71
    s_nop 0
    v_add_f32 v72, v72, v71
    v_sub_f32 v71, v65, v70
    v_mul_f32 v71, s66, v71
    v_exp_f32 v71, v71
    s_nop 0
    v_add_f32 v72, v72, v71
    v_sub_f32 v71, v66, v70
    v_mul_f32 v71, s66, v71
    v_exp_f32 v71, v71
    s_nop 0
    v_add_f32 v72, v72, v71
    v_sub_f32 v71, v67, v70
    v_mul_f32 v71, s66, v71
    v_exp_f32 v71, v71
    s_nop 0
    v_add_f32 v72, v72, v71
    s_nop 1
    v_add_f32_dpp v72, v72, v72 row_ror:8 row_mask:0xf bank_mask:0xf
    s_nop 1
    v_add_f32_dpp v72, v72, v72 row_ror:4 row_mask:0xf bank_mask:0xf
    s_nop 1
    v_add_f32_dpp v72, v72, v72 row_ror:2 row_mask:0xf bank_mask:0xf
    s_nop 1
    v_add_f32_dpp v72, v72, v72 row_ror:1 row_mask:0xf bank_mask:0xf
    v_mov_b32 v71, v72
    s_nop 1
    v_permlane16_swap_b32 v72, v71
    v_add_f32 v72, v72, v71
    v_mov_b32 v71, v72
    s_nop 1
    v_permlane32_swap_b32 v72, v71
    v_add_f32 v72, v72, v71
    v_min_u32 v74, v70, v14
    v_min_u32 v75, v72, v14
    s_lshl_b32 s66, s4, 9
    s_lshl_b32 s67, s80, 8
    s_add_u32 s66, s66, s67
    s_add_u32 s66, s66, s82
    s_add_u32 s66, s66, 32768
    s_lshl_b32 s67, s5, 1
    s_add_u32 s67, s67, s81
    s_lshl_b32 s67, s67, 3
    s_add_u32 s67, s67, s66
    v_mov_b32 v76, 0
    s_mov_b64 exec, 1
    buffer_store_dwordx2 v[74:75], v76, s[44:47], s67 offen sc1
    s_mov_b64 exec, -1
    v_lshlrev_b32 v76, 3, v13
    s_lshl_b32 s67, s15, 9
    s_add_u32 s83, s67, 768
    s_mov_b32 s68, 524288
L_spin_52:
    ds_read_b32 v9, v7 offset:44
    s_waitcnt lgkmcnt(0)
    v_readfirstlane_b32 s69, v9
    s_nop 0
    s_cmp_ge_u32 s69, s83
    s_cbranch_scc1 L_spind_53
    s_sub_u32 s68, s68, 1
    s_cbranch_scc1 L_abort
    s_sleep 4
    s_branch L_spin_52
L_spind_53:
    s_mov_b32 s68, 524288
L_pollml_54:
    buffer_load_dwordx2 v[74:75], v76, s[44:47], s66 offen sc1
    s_waitcnt vmcnt(0)
    v_max_u32 v9, v74, v75
    v_cmp_eq_u32 vcc, -1, v9
    s_cbranch_vccz L_polldml_55
    s_sub_u32 s68, s68, 1
    s_cbranch_scc1 L_abort
    s_sleep 16
    s_branch L_pollml_54
L_polldml_55:
    v_mov_b32 v70, v74
    s_nop 1
    v_max_f32_dpp v70, v70, v70 row_ror:8 row_mask:0xf bank_mask:0xf
    s_nop 1
    v_max_f32_dpp v70, v70, v70 row_ror:4 row_mask:0xf bank_mask:0xf
    s_nop 1
    v_max_f32_dpp v70, v70, v70 row_ror:2 row_mask:0xf bank_mask:0xf
    s_nop 1
    v_max_f32_dpp v70, v70, v70 row_ror:1 row_mask:0xf bank_mask:0xf
    v_mov_b32 v71, v70
    s_nop 1
    v_permlane16_swap_b32 v70, v71
    v_max_f32 v70, v70, v71
    s_mov_b32 s66, 1069066811
    v_sub_f32 v71, v74, v70
    v_mul_f32 v71, s66, v71
    v_exp_f32 v71, v71
    s_nop 0
    v_mul_f32 v72, v75, v71
    s_nop 1
    v_add_f32_dpp v72, v72, v72 row_ror:8 row_mask:0xf bank_mask:0xf
    s_nop 1
    v_add_f32_dpp v72, v72, v72 row_ror:4 row_mask:0xf bank_mask:0xf
    s_nop 1
    v_add_f32_dpp v72, v72, v72 row_ror:2 row_mask:0xf bank_mask:0xf
    s_nop 1
    v_add_f32_dpp v72, v72, v72 row_ror:1 row_mask:0xf bank_mask:0xf
    v_mov_b32 v71, v72
    s_nop 1
    v_permlane16_swap_b32 v72, v71
    v_add_f32 v72, v72, v71
    v_rcp_f32 v73, v72
    s_nop 0
    v_fma_f32 v71, -v72, v73, 1.0
    v_fma_f32 v73, v71, v73, v73
    v_sub_f32 v60, v60, v70
    v_mul_f32 v60, s66, v60
    v_exp_f32 v60, v60
    s_nop 0
    v_mul_f32 v60, v60, v73
    v_sub_f32 v61, v61, v70
    v_mul_f32 v61, s66, v61
    v_exp_f32 v61, v61
    s_nop 0
    v_mul_f32 v61, v61, v73
    v_sub_f32 v62, v62, v70
    v_mul_f32 v62, s66, v62
    v_exp_f32 v62, v62
    s_nop 0
    v_mul_f32 v62, v62, v73
    v_sub_f32 v63, v63, v70
    v_mul_f32 v63, s66, v63
    v_exp_f32 v63, v63
    s_nop 0
    v_mul_f32 v63, v63, v73
    v_sub_f32 v64, v64, v70
    v_mul_f32 v64, s66, v64
    v_exp_f32 v64, v64
    s_nop 0
    v_mul_f32 v64, v64, v73
    v_sub_f32 v65, v65, v70
    v_mul_f32 v65, s66, v65
    v_exp_f32 v65, v65
    s_nop 0
    v_mul_f32 v65, v65, v73
    v_sub_f32 v66, v66, v70
    v_mul_f32 v66, s66, v66
    v_exp_f32 v66, v66
    s_nop 0
    v_mul_f32 v66, v66, v73
    v_sub_f32 v67, v67, v70
    v_mul_f32 v67, s66, v67
    v_exp_f32 v67, v67
    s_nop 0
    v_mul_f32 v67, v67, v73
    v_cvt_pk_bf16_f32 v76, v60, v61
    v_cvt_pk_bf16_f32 v77, v62, v63
    v_cvt_pk_bf16_f32 v78, v64, v65
    v_cvt_pk_bf16_f32 v79, v66, v67
    v_lshrrev_b32 v56, 2, v1
    v_lshlrev_b32 v56, 7, v56
    v_and_b32 v57, 3, v1
    v_lshlrev_b32 v57, 4, v57
    v_add_u32 v56, v56, v57
    s_lshl_b32 s66, s80, 6
    s_lshl_b32 s67, s81, 11
    s_add_u32 s66, s66, s67
    s_lshl_b32 s67, s15, 12
    s_add_u32 s66, s66, s67
    s_add_u32 s66, s66, 126976
    v_add_u32 v56, s66, v56
    ds_write_b128 v56, v[76:79]
    ds_add_u32 v15, v8 offset:16
    s_cmp_eq_u32 s15, 0
    s_cbranch_scc0 L_mid_done
    s_cmp_eq_u32 s6, 0
    s_cbranch_scc1 L_fr_nonffn
    s_lshr_b32 s64, s12, 1
    s_mul_i32 s64, s64, 18432
    s_and_b32 s65, s12, 1
    s_lshl_b32 s65, s65, 5
    s_add_u32 s64, s64, s65
    v_add_u32 v56, s64, v3
    v_add_u32 v57, 36864, v56
    ds_read_b64_tr_b16 v[128:129], v56 offset:0
    ds_read_b64_tr_b16 v[130:131], v56 offset:256
    ds_read_b64_tr_b16 v[132:133], v56 offset:2048
    ds_read_b64_tr_b16 v[134:135], v56 offset:2304
    ds_read_b64_tr_b16 v[136:137], v56 offset:4096
    ds_read_b64_tr_b16 v[138:139], v56 offset:4352
    ds_read_b64_tr_b16 v[140:141], v56 offset:6144
    ds_read_b64_tr_b16 v[142:143], v56 offset:6400
    ds_read_b64_tr_b16 v[144:145], v56 offset:8192
    ds_read_b64_tr_b16 v[146:147], v56 offset:8448
    ds_read_b64_tr_b16 v[148:149], v56 offset:10240
    ds_read_b64_tr_b16 v[150:151], v56 offset:10496
    s_waitcnt lgkmcnt(0)
    ds_read_b64_tr_b16 v[152:153], v56 offset:12288
    ds_read_b64_tr_b16 v[154:155], v56 offset:12544
    ds_read_b64_tr_b16 v[156:157], v56 offset:14336
    ds_read_b64_tr_b16 v[158:159], v56 offset:14592
    ds_read_b64_tr_b16 v[160:161], v56 offset:16384
    ds_read_b64_tr_b16 v[162:163], v56 offset:16640
    s_waitcnt lgkmcnt(0)
    ds_read_b64_tr_b16 v[164:165], v57 offset:0
    ds_read_b64_tr_b16 v[166:167], v57 offset:256
    ds_read_b64_tr_b16 v[168:169], v57 offset:2048
    ds_read_b64_tr_b16 v[170:171], v57 offset:2304
    ds_read_b64_tr_b16 v[172:173], v57 offset:4096
    ds_read_b64_tr_b16 v[174:175], v57 offset:4352
    ds_read_b64_tr_b16 v[176:177], v57 offset:6144
    ds_read_b64_tr_b16 v[178:179], v57 offset:6400
    ds_read_b64_tr_b16 v[180:181], v57 offset:8192
    ds_read_b64_tr_b16 v[182:183], v57 offset:8448
    ds_read_b64_tr_b16 v[184:185], v57 offset:10240
    ds_read_b64_tr_b16 v[186:187], v57 offset:10496
    s_waitcnt lgkmcnt(0)
    ds_read_b64_tr_b16 v[188:189], v57 offset:12288
    ds_read_b64_tr_b16 v[190:191], v57 offset:12544
    ds_read_b64_tr_b16 v[192:193], v57 offset:14336
    ds_read_b64_tr_b16 v[194:195], v57 offset:14592
    ds_read_b64_tr_b16 v[196:197], v57 offset:16384
    ds_read_b64_tr_b16 v[198:199], v57 offset:16640
    s_waitcnt lgkmcnt(0)
    s_mul_i32 s64, s12, 288
    s_add_u32 s64, s64, 73728
    v_add_u32 v56, s64, v4
    ds_read_b64_tr_b16 v[200:201], v56 offset:0
    ds_read_b64_tr_b16 v[202:203], v56 offset:4608
    ds_read_b64_tr_b16 v[204:205], v56 offset:32
    ds_read_b64_tr_b16 v[206:207], v56 offset:4640
    ds_read_b64_tr_b16 v[208:209], v56 offset:64
    ds_read_b64_tr_b16 v[210:211], v56 offset:4672
    ds_read_b64_tr_b16 v[212:213], v56 offset:96
    ds_read_b64_tr_b16 v[214:215], v56 offset:4704
    ds_read_b64_tr_b16 v[216:217], v56 offset:128
    ds_read_b64_tr_b16 v[218:219], v56 offset:4736
    ds_read_b64_tr_b16 v[220:221], v56 offset:160
    ds_read_b64_tr_b16 v[222:223], v56 offset:4768
    s_waitcnt lgkmcnt(0)
    ds_read_b64_tr_b16 v[224:225], v56 offset:192
    ds_read_b64_tr_b16 v[226:227], v56 offset:4800
    ds_read_b64_tr_b16 v[228:229], v56 offset:224
    ds_read_b64_tr_b16 v[230:231], v56 offset:4832
    ds_read_b64_tr_b16 v[232:233], v56 offset:256
    ds_read_b64_tr_b16 v[234:235], v56 offset:4864
    s_waitcnt lgkmcnt(0)
    s_branch L_fr_done
L_fr_nonffn:
    s_mul_i32 s64, s12, 288
    s_add_u32 s64, s64, 0
    v_add_u32 v56, s64, v4
    ds_read_b64_tr_b16 v[128:129], v56 offset:0
    ds_read_b64_tr_b16 v[130:131], v56 offset:4608
    ds_read_b64_tr_b16 v[132:133], v56 offset:32
    ds_read_b64_tr_b16 v[134:135], v56 offset:4640
    ds_read_b64_tr_b16 v[136:137], v56 offset:64
    ds_read_b64_tr_b16 v[138:139], v56 offset:4672
    ds_read_b64_tr_b16 v[140:141], v56 offset:96
    ds_read_b64_tr_b16 v[142:143], v56 offset:4704
    ds_read_b64_tr_b16 v[144:145], v56 offset:128
    ds_read_b64_tr_b16 v[146:147], v56 offset:4736
    ds_read_b64_tr_b16 v[148:149], v56 offset:160
    ds_read_b64_tr_b16 v[150:151], v56 offset:4768
    s_waitcnt lgkmcnt(0)
    ds_read_b64_tr_b16 v[152:153], v56 offset:192
    ds_read_b64_tr_b16 v[154:155], v56 offset:4800
    ds_read_b64_tr_b16 v[156:157], v56 offset:224
    ds_read_b64_tr_b16 v[158:159], v56 offset:4832
    ds_read_b64_tr_b16 v[160:161], v56 offset:256
    ds_read_b64_tr_b16 v[162:163], v56 offset:4864
    s_waitcnt lgkmcnt(0)
    s_cmp_eq_u32 s10, 0
    s_cbranch_scc1 L_fr_done
    s_mul_i32 s64, s12, 288
    s_add_u32 s64, s64, 36864
    v_add_u32 v56, s64, v4
    ds_read_b64_tr_b16 v[164:165], v56 offset:0
    ds_read_b64_tr_b16 v[166:167], v56 offset:4608
    ds_read_b64_tr_b16 v[168:169], v56 offset:32
    ds_read_b64_tr_b16 v[170:171], v56 offset:4640
    ds_read_b64_tr_b16 v[172:173], v56 offset:64
    ds_read_b64_tr_b16 v[174:175], v56 offset:4672
    ds_read_b64_tr_b16 v[176:177], v56 offset:96
    ds_read_b64_tr_b16 v[178:179], v56 offset:4704
    ds_read_b64_tr_b16 v[180:181], v56 offset:128
    ds_read_b64_tr_b16 v[182:183], v56 offset:4736
    ds_read_b64_tr_b16 v[184:185], v56 offset:160
    ds_read_b64_tr_b16 v[186:187], v56 offset:4768
    s_waitcnt lgkmcnt(0)
    ds_read_b64_tr_b16 v[188:189], v56 offset:192
    ds_read_b64_tr_b16 v[190:191], v56 offset:4800
    ds_read_b64_tr_b16 v[192:193], v56 offset:224
    ds_read_b64_tr_b16 v[194:195], v56 offset:4832
    ds_read_b64_tr_b16 v[196:197], v56 offset:256
    ds_read_b64_tr_b16 v[198:199], v56 offset:4864
    s_waitcnt lgkmcnt(0)
L_fr_done:
    s_mov_b32 s15, 1
    v_add_u32 v15, 4, v15
    s_branch L_mid
L_mid_done:
    s_mov_b32 s68, 524288
L_spin_56:
    ds_read_b32 v9, v7 offset:24
    s_waitcnt lgkmcnt(0)
    v_readfirstlane_b32 s69, v9
    s_nop 0
    s_cmp_ge_u32 s69, 256
    s_cbranch_scc1 L_spind_57
    s_sub_u32 s68, s68, 1
    s_cbranch_scc1 L_abort
    s_sleep 4
    s_branch L_spin_56
L_spind_57:
    s_lshl_b32 s64, s12, 8
    s_add_u32 s65, s64, 135168
    v_lshlrev_b32 v56, 2, v1
    v_add_u32 v57, s65, v56
    ds_read_b32 v58, v57
    ds_read_b32 v59, v57 offset:1024
    ds_read_b32 v60, v57 offset:2048
    ds_read_b32 v61, v57 offset:3072
    s_lshl_b32 s65, s4, 14
    s_add_u32 s64, s64, s65
    s_lshl_b32 s65, s5, 10
    s_add_u32 s64, s64, s65
    s_add_u32 s64, s64, 65536
    s_waitcnt lgkmcnt(0)
    v_add_f32 v58, v58, v59
    v_add_f32 v60, v60, v61
    v_add_f32 v58, v58, v60
    v_min_u32 v58, v58, v14
    buffer_store_dword v58, v56, s[48:51], s64 offen sc1
    v_mov_b32 v56, 0
    v_mov_b32 v57, 155904
    ds_write_b32 v57, v56
    ds_write_b32 v57, v56 offset:4
    ds_write_b32 v57, v56 offset:8
    ds_write_b32 v57, v56 offset:12
    ds_write_b32 v57, v56 offset:512
    ds_write_b32 v57, v56 offset:516
    ds_write_b32 v57, v56 offset:520
    ds_write_b32 v57, v56 offset:524
    v_and_b32 v56, 7, v1
    v_lshlrev_b32 v56, 2, v56
    v_bfe_u32 v57, v1, 4, 1
    v_lshlrev_b32 v57, 1, v57
    v_add_u32 v56, v56, v57
    v_lshrrev_b32 v57, 5, v1
    v_add_u32 v56, v56, v57
    s_lshl_b32 s64, s12, 7
    s_add_u32 s65, s64, 154880
    v_lshlrev_b32 v57, 1, v56
    v_add_u32 v30, s65, v57
    s_add_u32 s66, s64, 154368
    v_lshlrev_b32 v57, 2, v56
    v_add_u32 v32, s66, v57
    v_lshlrev_b32 v57, 2, v13
    v_add_u32 v33, 154368, v57
    v_add_u32 v57, s65, v6
    v_mov_b32 v58, 155904
    v_cndmask_b32 v48, v58, v57, s[70:71]
    v_cndmask_b32 v49, v58, v57, s[72:73]
    v_cndmask_b32 v50, v58, v57, s[74:75]
    v_cndmask_b32 v51, v58, v57, s[76:77]
    s_lshl_b32 s64, s12, 8
    s_add_u32 s65, s64, 139264
    v_lshlrev_b32 v34, 2, v1
    v_add_u32 v35, s65, v34
    s_lshl_b32 s65, s4, 14
    s_add_u32 s64, s64, s65
    s_lshl_b32 s65, s5, 10
    s_add_u32 s64, s64, s65
    s_add_u32 s60, s64, 327680
    s_mov_b32 s65, 14336
    s_mov_b32 s66, 589824
    s_cmp_eq_u32 s6, 1
    s_cselect_b32 s65, 18432, s65
    s_cselect_b32 s66, 1179648, s66
    s_lshl_b32 s82, s7, 7
    s_add_u32 s82, s82, s66
    s_add_u32 s83, s82, s65
    s_cmp_eq_u32 s6, 1
    s_cbranch_scc1 L_t_ffn
    v_lshrrev_b32 v56, 3, v1
    v_lshlrev_b32 v56, 11, v56
    v_and_b32 v57, 7, v1
    v_lshlrev_b32 v57, 4, v57
    v_add_u32 v31, v56, v57
    s_add_u32 s66, s7, 0
    s_lshr_b32 s64, s66, 3
    s_lshl_b32 s64, s64, 14
    s_and_b32 s65, s66, 7
    s_lshl_b32 s65, s65, 7
    s_add_u32 s64, s64, s65
    s_add_u32 s80, s64, 65536
    s_add_u32 s66, s7, 16
    s_lshr_b32 s64, s66, 3
    s_lshl_b32 s64, s64, 14
    s_and_b32 s65, s66, 7
    s_lshl_b32 s65, s65, 7
    s_add_u32 s64, s64, s65
    s_add_u32 s81, s64, 65536
    s_mov_b32 s68, 524288
L_spin_58:
    ds_read_b32 v9, v7 offset:44
    s_waitcnt lgkmcnt(0)
    v_readfirstlane_b32 s69, v9
    s_nop 0
    s_cmp_ge_u32 s69, 1792
    s_cbranch_scc1 L_spind_59
    s_sub_u32 s68, s68, 1
    s_cbranch_scc1 L_abort
    s_sleep 4
    s_branch L_spin_58
L_spind_59:
    s_cmp_eq_u32 s10, 1
    s_cbranch_scc1 L_t_b0two
    s_mov_b32 s68, 524288
    buffer_load_dwordx4 v[108:111], v31, s[44:47], s80 offen offset:0 sc1
    buffer_load_dwordx4 v[112:115], v31, s[44:47], s80 offen offset:1024 sc1
L_p2al_60:
    s_waitcnt vmcnt(0)
    v_max_u32 v9, v108, v109
    v_max3_u32 v9, v9, v110, v111
    v_max3_u32 v9, v9, v112, v113
    v_max3_u32 v9, v9, v114, v115
    v_cmp_eq_u32 vcc, -1, v9
    s_cbranch_vccz L_p2aa_61
    s_sub_u32 s68, s68, 1
    s_cbranch_scc1 L_abort
    buffer_load_dwordx4 v[108:111], v31, s[44:47], s80 offen offset:0 sc1
    buffer_load_dwordx4 v[112:115], v31, s[44:47], s80 offen offset:1024 sc1
    s_branch L_p2al_60
L_p2aa_61:
    v_add_f32 v64, v108, v112
    v_add_f32 v65, v109, v113
    v_add_f32 v66, v110, v114
    v_add_f32 v67, v111, v115
    v_permlane32_swap_b32 v64, v65
    s_nop 0
    v_permlane32_swap_b32 v66, v67
    v_add_f32 v64, v64, v65
    v_add_f32 v66, v66, v67
    s_nop 1
    v_permlane16_swap_b32 v64, v66
    v_add_f32 v64, v64, v66
    s_nop 1
    v_add_f32_dpp v64, v64, v64 row_ror:8 row_mask:0xf bank_mask:0xf
    v_cvt_pk_bf16_f32 v64, v64, v64
    ds_write_b16 v30, v64 offset:0
    s_branch L_t_b0done
L_t_b0two:
    s_mov_b32 s68, 524288
    buffer_load_dwordx4 v[108:111], v31, s[44:47], s80 offen offset:0 sc1
    buffer_load_dwordx4 v[112:115], v31, s[44:47], s80 offen offset:1024 sc1
    buffer_load_dwordx4 v[116:119], v31, s[44:47], s81 offen offset:0 sc1
    buffer_load_dwordx4 v[120:123], v31, s[44:47], s81 offen offset:1024 sc1
L_p2bl_64:
    s_waitcnt vmcnt(0)
    v_max_u32 v9, v108, v109
    v_max3_u32 v9, v9, v110, v111
    v_max3_u32 v9, v9, v112, v113
    v_max3_u32 v9, v9, v114, v115
    v_max3_u32 v9, v9, v116, v117
    v_max3_u32 v9, v9, v118, v119
    v_max3_u32 v9, v9, v120, v121
    v_max3_u32 v9, v9, v122, v123
    v_cmp_eq_u32 vcc, -1, v9
    s_cbranch_vccz L_p2ba_65
    s_sub_u32 s68, s68, 1
    s_cbranch_scc1 L_abort
    buffer_load_dwordx4 v[108:111], v31, s[44:47], s80 offen offset:0 sc1
    buffer_load_dwordx4 v[112:115], v31, s[44:47], s80 offen offset:1024 sc1
    buffer_load_dwordx4 v[116:119], v31, s[44:47], s81 offen offset:0 sc1
    buffer_load_dwordx4 v[120:123], v31, s[44:47], s81 offen offset:1024 sc1
    s_branch L_p2bl_64
L_p2ba_65:
    v_add_f32 v64, v108, v112
    v_add_f32 v65, v109, v113
    v_add_f32 v66, v110, v114
    v_add_f32 v67, v111, v115
    v_add_f32 v68, v116, v120
    v_add_f32 v69, v117, v121
    v_add_f32 v70, v118, v122
    v_add_f32 v71, v119, v123
    v_permlane32_swap_b32 v64, v65
    v_permlane32_swap_b32 v66, v67
    v_add_f32 v64, v64, v65
    v_add_f32 v66, v66, v67
    s_nop 1
    v_permlane16_swap_b32 v64, v66
    v_add_f32 v64, v64, v66
    s_nop 1
    v_add_f32_dpp v64, v64, v64 row_ror:8 row_mask:0xf bank_mask:0xf
    v_permlane32_swap_b32 v68, v69
    v_permlane32_swap_b32 v70, v71
    v_add_f32 v68, v68, v69
    v_add_f32 v70, v70, v71
    s_nop 1
    v_permlane16_swap_b32 v68, v70
    v_add_f32 v68, v68, v70
    s_nop 1
    v_add_f32_dpp v68, v68, v68 row_ror:8 row_mask:0xf bank_mask:0xf
    v_cvt_pk_bf16_f32 v64, v64, v64
    ds_write_b16 v30, v64 offset:0
    v_cvt_pk_bf16_f32 v68, v68, v68
    ds_write_b16 v30, v68 offset:512
L_t_b0done:
    s_add_u32 s80, s80, 262144
    s_add_u32 s81, s81, 262144
    s_max_i32 s67, s11, 0
    s_mul_i32 s64, s67, 14336
    s_add_u32 s64, s64, 589824
    s_add_u32 s52, s42, s64
    s_addc_u32 s53, s43, 0
    s_mov_b32 s54, 14336
    s_mov_b32 s55, 0x20000
    s_mul_i32 s64, s67, 18432
    s_add_u32 s64, s64, 1179648
    s_add_u32 s56, s42, s64
    s_addc_u32 s57, s43, 0
    s_mov_b32 s58, 18432
    s_mov_b32 s59, 0x20000
    s_lshl_b32 s65, s12, 10
    v_lshlrev_b32 v36, 4, v1
    v_add_u32 v36, s65, v36
    v_add_u32 v37, 4096, v36
    v_add_u32 v38, 8192, v36
    v_add_u32 v39, 12288, v36
    v_add_u32 v40, 16384, v36
    s_and_b32 s61, s11, 1
    s_mul_i32 s61, s61, 1152
    s_lshr_b32 s65, s11, 1
    s_lshl_b32 s65, s65, 6
    s_add_u32 s61, s61, s65
    v_lshrrev_b32 v41, 1, v13
    v_lshlrev_b32 v41, 2, v41
    s_mov_b32 s68, 524288
L_spin_68:
    ds_read_b32 v9, v7 offset:28
    s_waitcnt lgkmcnt(0)
    v_readfirstlane_b32 s69, v9
    s_nop 0
    s_cmp_ge_u32 s69, 256
    s_cbranch_scc1 L_spind_69
    s_sub_u32 s68, s68, 1
    s_cbranch_scc1 L_abort
    s_branch L_spin_68
L_spind_69:
    ds_read_b32 v64, v35
    ds_read_b32 v65, v35 offset:1024
    ds_read_b32 v66, v35 offset:2048
    ds_read_b32 v67, v35 offset:3072
    s_waitcnt lgkmcnt(2)
    v_add_f32 v64, v64, v65
    s_waitcnt lgkmcnt(0)
    v_add_f32 v66, v66, v67
    v_add_f32 v64, v64, v66
    v_min_u32 v64, v64, v14
    buffer_store_dword v64, v34, s[48:51], s60 offen sc1
    s_cmp_eq_u32 s10, 1
    s_cbranch_scc1 L_t_two
    s_mov_b32 s68, 524288
    buffer_load_dwordx4 v[108:111], v31, s[44:47], s80 offen offset:0 sc1
    buffer_load_dwordx4 v[112:115], v31, s[44:47], s80 offen offset:1024 sc1
L_p2cl_70:
    s_waitcnt vmcnt(0)
    v_max_u32 v9, v108, v109
    v_max3_u32 v9, v9, v110, v111
    v_max3_u32 v9, v9, v112, v113
    v_max3_u32 v9, v9, v114, v115
    v_cmp_eq_u32 vcc, -1, v9
    s_cbranch_vccz L_p2ca_71
    s_sub_u32 s68, s68, 1
    s_cbranch_scc1 L_abort
    buffer_load_dwordx4 v[108:111], v31, s[44:47], s80 offen offset:0 sc1
    buffer_load_dwordx4 v[112:115], v31, s[44:47], s80 offen offset:1024 sc1
    s_branch L_p2cl_70
L_p2ca_71:
    v_add_f32 v64, v108, v112
    v_add_f32 v65, v109, v113
    v_add_f32 v66, v110, v114
    v_add_f32 v67, v111, v115
    v_permlane32_swap_b32 v64, v65
    s_nop 0
    v_permlane32_swap_b32 v66, v67
    v_add_f32 v64, v64, v65
    v_add_f32 v66, v66, v67
    s_nop 1
    v_permlane16_swap_b32 v64, v66
    v_add_f32 v64, v64, v66
    s_nop 1
    v_add_f32_dpp v64, v64, v64 row_ror:8 row_mask:0xf bank_mask:0xf
    v_cvt_pk_bf16_f32 v64, v64, v64
    ds_write_b16 v30, v64 offset:64
    ds_read_b128 v[80:83], v48
    ds_read_b128 v[84:87], v49
    ds_read_b128 v[88:91], v50
    ds_read_b128 v[92:95], v51
    s_waitcnt lgkmcnt(0)
    v_mfma_f32_16x16x32_bf16 v[96:99], v[80:83], v[128:131], 0
    v_mfma_f32_16x16x32_bf16 v[96:99], v[84:87], v[132:135], v[96:99]
    v_mfma_f32_16x16x32_bf16 v[96:99], v[88:91], v[136:139], v[96:99]
    v_mfma_f32_16x16x32_bf16 v[96:99], v[92:95], v[140:143], v[96:99]
    v_mfma_f32_16x16x32_bf16 v[100:103], v[80:83], v[144:147], 0
    v_mfma_f32_16x16x32_bf16 v[100:103], v[84:87], v[148:151], v[100:103]
    v_mfma_f32_16x16x32_bf16 v[100:103], v[88:91], v[152:155], v[100:103]
    v_mfma_f32_16x16x32_bf16 v[100:103], v[92:95], v[156:159], v[100:103]
    v_mfma_f32_16x16x32_bf16 v[104:107], v[80:83], v[160:163], 0
    s_branch L_t_no2
L_t_two:
    s_mov_b32 s68, 524288
    buffer_load_dwordx4 v[108:111], v31, s[44:47], s80 offen offset:0 sc1
    buffer_load_dwordx4 v[112:115], v31, s[44:47], s80 offen offset:1024 sc1
    buffer_load_dwordx4 v[116:119], v31, s[44:47], s81 offen offset:0 sc1
    buffer_load_dwordx4 v[120:123], v31, s[44:47], s81 offen offset:1024 sc1
L_p2dl_74:
    s_waitcnt vmcnt(0)
    v_max_u32 v9, v108, v109
    v_max3_u32 v9, v9, v110, v111
    v_max3_u32 v9, v9, v112, v113
    v_max3_u32 v9, v9, v114, v115
    v_max3_u32 v9, v9, v116, v117
    v_max3_u32 v9, v9, v118, v119
    v_max3_u32 v9, v9, v120, v121
    v_max3_u32 v9, v9, v122, v123
    v_cmp_eq_u32 vcc, -1, v9
    s_cbranch_vccz L_p2da_75
    s_sub_u32 s68, s68, 1
    s_cbranch_scc1 L_abort
    buffer_load_dwordx4 v[108:111], v31, s[44:47], s80 offen offset:0 sc1
    buffer_load_dwordx4 v[112:115], v31, s[44:47], s80 offen offset:1024 sc1
    buffer_load_dwordx4 v[116:119], v31, s[44:47], s81 offen offset:0 sc1
    buffer_load_dwordx4 v[120:123], v31, s[44:47], s81 offen offset:1024 sc1
    s_branch L_p2dl_74
L_p2da_75:
    v_add_f32 v64, v108, v112
    v_add_f32 v65, v109, v113
    v_add_f32 v66, v110, v114
    v_add_f32 v67, v111, v115
    v_add_f32 v68, v116, v120
    v_add_f32 v69, v117, v121
    v_add_f32 v70, v118, v122
    v_add_f32 v71, v119, v123
    v_permlane32_swap_b32 v64, v65
    v_permlane32_swap_b32 v66, v67
    v_add_f32 v64, v64, v65
    v_add_f32 v66, v66, v67
    s_nop 1
    v_permlane16_swap_b32 v64, v66
    v_add_f32 v64, v64, v66
    s_nop 1
    v_add_f32_dpp v64, v64, v64 row_ror:8 row_mask:0xf bank_mask:0xf
    v_permlane32_swap_b32 v68, v69
    v_permlane32_swap_b32 v70, v71
    v_add_f32 v68, v68, v69
    v_add_f32 v70, v70, v71
    s_nop 1
    v_permlane16_swap_b32 v68, v70
    v_add_f32 v68, v68, v70
    s_nop 1
    v_add_f32_dpp v68, v68, v68 row_ror:8 row_mask:0xf bank_mask:0xf
    v_cvt_pk_bf16_f32 v64, v64, v64
    ds_write_b16 v30, v64 offset:64
    v_cvt_pk_bf16_f32 v68, v68, v68
    ds_write_b16 v30, v68 offset:576
    ds_read_b128 v[80:83], v48
    ds_read_b128 v[84:87], v49
    ds_read_b128 v[88:91], v50
    ds_read_b128 v[92:95], v51
    v_add_u32 v48, 512, v48
    v_add_u32 v49, 512, v49
    v_add_u32 v50, 512, v50
    v_add_u32 v51, 512, v51
    ds_read_b128 v[64:67], v48
    ds_read_b128 v[68:71], v49
    ds_read_b128 v[72:75], v50
    ds_read_b128 v[76:79], v51
    s_waitcnt lgkmcnt(4)
    v_mfma_f32_16x16x32_bf16 v[96:99], v[80:83], v[128:131], 0
    v_mfma_f32_16x16x32_bf16 v[96:99], v[84:87], v[132:135], v[96:99]
    v_mfma_f32_16x16x32_bf16 v[96:99], v[88:91], v[136:139], v[96:99]
    v_mfma_f32_16x16x32_bf16 v[96:99], v[92:95], v[140:143], v[96:99]
    v_mfma_f32_16x16x32_bf16 v[100:103], v[80:83], v[144:147], 0
    v_mfma_f32_16x16x32_bf16 v[100:103], v[84:87], v[148:151], v[100:103]
    v_mfma_f32_16x16x32_bf16 v[100:103], v[88:91], v[152:155], v[100:103]
    v_mfma_f32_16x16x32_bf16 v[100:103], v[92:95], v[156:159], v[100:103]
    v_mfma_f32_16x16x32_bf16 v[104:107], v[80:83], v[160:163], 0
    s_waitcnt lgkmcnt(0)
    v_mfma_f32_16x16x32_bf16 v[96:99], v[64:67], v[164:167], v[96:99]
    v_mfma_f32_16x16x32_bf16 v[96:99], v[68:71], v[168:171], v[96:99]
    v_mfma_f32_16x16x32_bf16 v[96:99], v[72:75], v[172:175], v[96:99]
    v_mfma_f32_16x16x32_bf16 v[96:99], v[76:79], v[176:179], v[96:99]
    v_mfma_f32_16x16x32_bf16 v[100:103], v[64:67], v[180:183], v[100:103]
    v_mfma_f32_16x16x32_bf16 v[100:103], v[68:71], v[184:187], v[100:103]
    v_mfma_f32_16x16x32_bf16 v[100:103], v[72:75], v[188:191], v[100:103]
    v_mfma_f32_16x16x32_bf16 v[100:103], v[76:79], v[192:195], v[100:103]
    v_mfma_f32_16x16x32_bf16 v[104:107], v[64:67], v[196:199], v[104:107]
L_t_no2:
    s_nop 2
    v_min_u32 v96, v96, v14
    buffer_store_dword v96, v10, s[48:51], s82 offen sc1
    v_min_u32 v97, v97, v14
    buffer_store_dword v97, v10, s[48:51], s83 offen sc1
    v_min_u32 v100, v100, v14
    buffer_store_dword v100, v11, s[48:51], s82 offen sc1
    v_min_u32 v101, v101, v14
    buffer_store_dword v101, v11, s[48:51], s83 offen sc1
    s_mov_b64 exec, 0xffff
    v_min_u32 v104, v104, v14
    buffer_store_dword v104, v12, s[48:51], s82 offen sc1
    v_min_u32 v105, v105, v14
    buffer_store_dword v105, v12, s[48:51], s83 offen sc1
    s_mov_b64 exec, -1
    s_cmp_eq_u32 s11, -1
    s_cbranch_scc1 L_t_end
    s_mov_b32 s68, 524288
    buffer_load_dwordx4 v[108:111], v36, s[52:55], 0 offen sc1
    buffer_load_dwordx4 v[112:115], v37, s[52:55], 0 offen sc1
    buffer_load_dwordx4 v[116:119], v38, s[52:55], 0 offen sc1
    buffer_load_dwordx4 v[120:123], v39, s[52:55], 0 offen sc1
L_p2yl_78:
    s_waitcnt vmcnt(0)
    v_max_u32 v9, v108, v109
    v_max3_u32 v9, v9, v110, v111
    v_max3_u32 v9, v9, v112, v113
    v_max3_u32 v9, v9, v114, v115
    v_max3_u32 v9, v9, v116, v117
    v_max3_u32 v9, v9, v118, v119
    v_max3_u32 v9, v9, v120, v121
    v_max3_u32 v9, v9, v122, v123
    v_cmp_eq_u32 vcc, -1, v9
    s_cbranch_vccz L_p2ya_79
    s_sub_u32 s68, s68, 1
    s_cbranch_scc1 L_abort
    buffer_load_dwordx4 v[108:111], v36, s[52:55], 0 offen sc1
    buffer_load_dwordx4 v[112:115], v37, s[52:55], 0 offen sc1
    buffer_load_dwordx4 v[116:119], v38, s[52:55], 0 offen sc1
    buffer_load_dwordx4 v[120:123], v39, s[52:55], 0 offen sc1
    s_branch L_p2yl_78
L_p2ya_79:
    v_add_f32 v64, v108, v112
    v_add_f32 v65, v109, v113
    v_add_f32 v66, v110, v114
    v_add_f32 v67, v111, v115
    v_add_f32 v64, v64, v116
    v_add_f32 v65, v65, v117
    v_add_f32 v66, v66, v118
    v_add_f32 v67, v67, v119
    v_add_f32 v64, v64, v120
    v_add_f32 v65, v65, v121
    v_add_f32 v66, v66, v122
    v_add_f32 v67, v67, v123
    v_permlane32_swap_b32 v64, v65
    s_nop 0
    v_permlane32_swap_b32 v66, v67
    v_add_f32 v64, v64, v65
    v_add_f32 v66, v66, v67
    s_nop 1
    v_permlane16_swap_b32 v64, v66
    v_add_f32 v64, v64, v66
    s_nop 1
    v_add_f32_dpp v64, v64, v64 row_ror:8 row_mask:0xf bank_mask:0xf
    ds_write_b32 v32, v64
    s_waitcnt lgkmcnt(0)
    s_barrier
    ds_read_b32 v60, v33
    ds_read_b32 v61, v33 offset:128
    ds_read_b32 v62, v33 offset:256
    ds_read_b32 v63, v33 offset:384
    s_waitcnt lgkmcnt(2)
    v_add_f32 v60, v60, v61
    s_waitcnt lgkmcnt(0)
    v_add_f32 v62, v62, v63
    v_add_f32 v60, v60, v62
    s_cmp_lg_u32 s12, 0
    s_cbranch_scc1 L_t_x1done
    v_cvt_pk_bf16_f32 v62, v60, v60
    v_and_b32 v60, 0xffff0000, v62
    v_mul_f32 v60, v52, v60
    v_cvt_pk_bf16_f32 v62, v60, v60
    v_and_b32 v60, 0xffff0000, v62
    v_add_f32 v60, v54, v60
    s_nop 1
    v_mov_b32_dpp v62, v60 quad_perm:[1,0,3,2] row_mask:0xf bank_mask:0xf
    v_cvt_pk_bf16_f32 v62, v60, v62
    v_min_u32 v62, v62, v14
    s_add_u32 s64, s61, 1114112
    s_mov_b32 exec_hi, 0
    s_mov_b32 exec_lo, 0x55555555
    buffer_store_dword v62, v41, s[48:51], s64 offen offset:0 sc1
    s_mov_b64 exec, -1
    v_cvt_pk_bf16_f32 v63, v60, v60
    v_and_b32 v60, 0xffff0000, v63
    v_mov_b32 v55, v60
L_t_x1done:
    s_barrier
    s_mov_b32 s68, 524288
    buffer_load_dwordx4 v[108:111], v36, s[56:59], 0 offen sc1
    buffer_load_dwordx4 v[112:115], v37, s[56:59], 0 offen sc1
    buffer_load_dwordx4 v[116:119], v38, s[56:59], 0 offen sc1
    buffer_load_dwordx4 v[120:123], v39, s[56:59], 0 offen sc1
    buffer_load_dwordx4 v[124:127], v40, s[56:59], 0 offen sc1
L_p2fl_82:
    s_waitcnt vmcnt(0)
    v_max_u32 v9, v108, v109
    v_max3_u32 v9, v9, v110, v111
    v_max3_u32 v9, v9, v112, v113
    v_max3_u32 v9, v9, v114, v115
    v_max3_u32 v9, v9, v116, v117
    v_max3_u32 v9, v9, v118, v119
    v_max3_u32 v9, v9, v120, v121
    v_max3_u32 v9, v9, v122, v123
    v_max3_u32 v9, v9, v124, v125
    v_max3_u32 v9, v9, v126, v127
    v_cmp_eq_u32 vcc, -1, v9
    s_cbranch_vccz L_p2fa_83
    s_sub_u32 s68, s68, 1
    s_cbranch_scc1 L_abort
    buffer_load_dwordx4 v[108:111], v36, s[56:59], 0 offen sc1
    buffer_load_dwordx4 v[112:115], v37, s[56:59], 0 offen sc1
    buffer_load_dwordx4 v[116:119], v38, s[56:59], 0 offen sc1
    buffer_load_dwordx4 v[120:123], v39, s[56:59], 0 offen sc1
    buffer_load_dwordx4 v[124:127], v40, s[56:59], 0 offen sc1
    s_branch L_p2fl_82
L_p2fa_83:
    v_add_f32 v64, v108, v112
    v_add_f32 v65, v109, v113
    v_add_f32 v66, v110, v114
    v_add_f32 v67, v111, v115
    v_add_f32 v64, v64, v116
    v_add_f32 v65, v65, v117
    v_add_f32 v66, v66, v118
    v_add_f32 v67, v67, v119
    v_add_f32 v64, v64, v120
    v_add_f32 v65, v65, v121
    v_add_f32 v66, v66, v122
    v_add_f32 v67, v67, v123
    v_add_f32 v64, v64, v124
    v_add_f32 v65, v65, v125
    v_add_f32 v66, v66, v126
    v_add_f32 v67, v67, v127
    v_permlane32_swap_b32 v64, v65
    s_nop 0
    v_permlane32_swap_b32 v66, v67
    v_add_f32 v64, v64, v65
    v_add_f32 v66, v66, v67
    s_nop 1
    v_permlane16_swap_b32 v64, v66
    v_add_f32 v64, v64, v66
    s_nop 1
    v_add_f32_dpp v64, v64, v64 row_ror:8 row_mask:0xf bank_mask:0xf
    ds_write_b32 v32, v64
    s_waitcnt lgkmcnt(0)
    s_barrier
    ds_read_b32 v60, v33
    ds_read_b32 v61, v33 offset:128
    ds_read_b32 v62, v33 offset:256
    ds_read_b32 v63, v33 offset:384
    s_waitcnt lgkmcnt(2)
    v_add_f32 v60, v60, v61
    s_waitcnt lgkmcnt(0)
    v_add_f32 v62, v62, v63
    v_add_f32 v60, v60, v62
    s_cmp_lg_u32 s12, 0
    s_cbranch_scc1 L_t_end
    v_cvt_pk_bf16_f32 v62, v60, v60
    v_and_b32 v60, 0xffff0000, v62
    v_mul_f32 v60, v53, v60
    v_cvt_pk_bf16_f32 v62, v60, v60
    v_and_b32 v60, 0xffff0000, v62
    v_add_f32 v60, v55, v60
    s_nop 1
    v_mov_b32_dpp v62, v60 quad_perm:[1,0,3,2] row_mask:0xf bank_mask:0xf
    v_cvt_pk_bf16_f32 v62, v60, v62
    s_mov_b32 s52, s38
    s_mov_b32 s53, s39
    s_mov_b32 s54, 2304
    s_mov_b32 s55, 0x20000
    s_mov_b32 exec_hi, 0
    s_mov_b32 exec_lo, 0x55555555
    buffer_store_dword v62, v41, s[52:55], s61 offen
    s_mov_b64 exec, -1
    s_cmp_lg_u32 s11, 0
    s_cbranch_scc1 L_t_end
    v_mov_b32 v61, 28672
    v_mov_b32 v62, s79
    s_mov_b64 exec, 1
    buffer_store_dword v62, v61, s[48:51], 0 offen sc1
    s_mov_b64 exec, -1
    s_branch L_t_end
L_t_ffn:
    s_lshr_b32 s64, s12, 1
    s_mul_i32 s64, s64, 576
    s_add_u32 s64, s64, 150016
    v_add_u32 v108, s64, v5
    v_and_b32 v60, 15, v1
    v_lshlrev_b32 v60, 2, v60
    s_lshl_b32 s64, s12, 8
    s_add_u32 s64, s64, 153344
    v_add_u32 v92, s64, v60
    v_bfe_u32 v93, v1, 4, 1
    v_lshlrev_b32 v93, 8, v93
    v_lshrrev_b32 v94, 5, v1
    v_lshlrev_b32 v94, 6, v94
    v_add_u32 v93, v93, v94
    v_add_u32 v93, v93, v60
    v_add_u32 v93, 153344, v93
    v_lshlrev_b32 v95, 1, v13
    v_add_u32 v94, v94, v95
    s_lshl_b32 s64, s12, 7
    s_add_u32 s64, s64, 154880
    v_add_u32 v94, s64, v94
    v_add_u32 v95, s64, v6
    v_add_u32 v109, 150016, v28
    v_mov_b32 v112, 0
    v_mov_b32 v113, 0
    v_mov_b32 v114, 0
    v_mov_b32 v116, 0
    v_mov_b32 v117, 0
    v_mov_b32 v118, 0
    v_mov_b32 v244, 0
    v_mov_b32 v245, 0
    v_mov_b32 v246, 0
    v_mov_b32 v248, 0
    v_mov_b32 v249, 0
    v_mov_b32 v250, 0
    v_mov_b32 v56, 0
    v_mov_b32 v57, 0
    v_mov_b32 v58, 0
    v_mov_b32 v60, 0
    v_mov_b32 v61, 0
    v_mov_b32 v62, 0
    s_mul_i32 s80, s12, 0
    s_add_u32 s80, s80, 1114112
    s_mov_b32 s68, 524288
L_spin_86:
    ds_read_b32 v9, v7 offset:28
    s_waitcnt lgkmcnt(0)
    v_readfirstlane_b32 s69, v9
    s_nop 0
    s_cmp_ge_u32 s69, 256
    s_cbranch_scc1 L_spind_87
    s_sub_u32 s68, s68, 1
    s_cbranch_scc1 L_abort
    s_branch L_spin_86
L_spind_87:
    ds_read_b32 v64, v35
    ds_read_b32 v65, v35 offset:1024
    ds_read_b32 v66, v35 offset:2048
    ds_read_b32 v67, v35 offset:3072
    s_waitcnt lgkmcnt(2)
    v_add_f32 v64, v64, v65
    s_waitcnt lgkmcnt(0)
    v_add_f32 v66, v66, v67
    v_add_f32 v64, v64, v66
    v_min_u32 v64, v64, v14
    buffer_store_dword v64, v34, s[48:51], s60 offen sc1
    s_mov_b32 exec_hi, 0xffff
    s_mov_b32 s68, 524288
    buffer_load_dwordx3 v[112:114], v28, s[44:47], s80 offen sc1
    buffer_load_dwordx3 v[116:118], v29, s[44:47], s80 offen sc1
L_p2xl_88:
    s_waitcnt vmcnt(0)
    v_max_u32 v9, v112, v113
    v_max3_u32 v9, v9, v114, v116
    v_max3_u32 v9, v9, v117, v118
    v_cmp_eq_u32 vcc, -1, v9
    s_cbranch_vccz L_p2xa_89
    s_sub_u32 s68, s68, 1
    s_cbranch_scc1 L_abort
    buffer_load_dwordx3 v[112:114], v28, s[44:47], s80 offen sc1
    buffer_load_dwordx3 v[116:118], v29, s[44:47], s80 offen sc1
    s_branch L_p2xl_88
L_p2xa_89:
    v_mov_b32 v56, v112
    v_mov_b32 v60, v116
    v_mov_b32 v57, v113
    v_mov_b32 v61, v117
    v_mov_b32 v58, v114
    v_mov_b32 v62, v118
    s_mov_b64 exec, -1
    s_mov_b32 s65, 0x3f803f80
    v_dot2_f32_bf16 v64, v56, s65, 0
    v_dot2_f32_bf16 v65, v56, v56, 0
    v_dot2_f32_bf16 v64, v57, s65, v64
    v_dot2_f32_bf16 v65, v57, v57, v65
    v_dot2_f32_bf16 v64, v58, s65, v64
    v_dot2_f32_bf16 v65, v58, v58, v65
    v_dot2_f32_bf16 v64, v60, s65, v64
    v_dot2_f32_bf16 v65, v60, v60, v65
    v_dot2_f32_bf16 v64, v61, s65, v64
    v_dot2_f32_bf16 v65, v61, v61, v65
    v_dot2_f32_bf16 v64, v62, s65, v64
    v_dot2_f32_bf16 v65, v62, v62, v65
    v_lshlrev_b32 v66, 16, v56
    v_and_b32 v67, 0xffff0000, v56
    v_lshlrev_b32 v68, 16, v57
    v_and_b32 v69, 0xffff0000, v57
    v_lshlrev_b32 v70, 16, v58
    v_and_b32 v71, 0xffff0000, v58
    v_add_f32_dpp v64, v64, v64 row_ror:8 row_mask:0xf bank_mask:0xf
    v_add_f32_dpp v65, v65, v65 row_ror:8 row_mask:0xf bank_mask:0xf
    s_nop 0
    v_add_f32_dpp v64, v64, v64 row_ror:4 row_mask:0xf bank_mask:0xf
    v_add_f32_dpp v65, v65, v65 row_ror:4 row_mask:0xf bank_mask:0xf
    s_nop 0
    v_add_f32_dpp v64, v64, v64 row_ror:2 row_mask:0xf bank_mask:0xf
    v_add_f32_dpp v65, v65, v65 row_ror:2 row_mask:0xf bank_mask:0xf
    s_nop 0
    v_add_f32_dpp v64, v64, v64 row_ror:1 row_mask:0xf bank_mask:0xf
    v_add_f32_dpp v65, v65, v65 row_ror:1 row_mask:0xf bank_mask:0xf
    s_nop 1
    v_permlane32_swap_b32 v64, v65
    v_add_f32 v64, v64, v65
    v_mov_b32 v65, v64
    s_nop 1
    v_permlane16_swap_b32 v64, v65
    v_add_f32 v64, v64, v65
    s_nop 0
    v_readlane_b32 s65, v64, 0
    v_readlane_b32 s66, v64, 32
    v_mov_b32 v72, 0x3ae38e39
    v_mul_f32 v74, s65, v72
    v_mul_f32 v75, s66, v72
    v_fma_f32 v75, -v74, v74, v75
    v_cvt_pk_bf16_f32 v76, v74, v75
    v_lshlrev_b32 v74, 16, v76
    v_and_b32 v75, 0xffff0000, v76
    v_add_f32 v75, 0x3727c5ac, v75
    v_cvt_pk_bf16_f32 v76, v75, v75
    v_and_b32 v75, 0xffff0000, v76
    v_sqrt_f32 v75, v75
    s_nop 0
    v_cvt_pk_bf16_f32 v76, v75, v75
    v_and_b32 v75, 0xffff0000, v76
    v_rcp_f32 v78, v75
    v_mov_b32 v73, v74
    v_sub_f32 v72, 0, v74
    v_mov_b32 v73, v72
    v_mov_b32 v79, v78
    v_sub_f32 v76, 0, v75
    v_mov_b32 v77, v76
    v_pk_add_f32 v[66:67], v[66:67], v[72:73]
    v_pk_add_f32 v[68:69], v[68:69], v[72:73]
    v_pk_add_f32 v[70:71], v[70:71], v[72:73]
    v_cvt_pk_bf16_f32 v56, v66, v67
    v_cvt_pk_bf16_f32 v57, v68, v69
    v_cvt_pk_bf16_f32 v58, v70, v71
    v_lshlrev_b32 v66, 16, v56
    v_and_b32 v67, 0xffff0000, v56
    v_lshlrev_b32 v68, 16, v57
    v_and_b32 v69, 0xffff0000, v57
    v_lshlrev_b32 v70, 16, v58
    v_and_b32 v71, 0xffff0000, v58
    v_pk_mul_f32 v[80:81], v[66:67], v[78:79]
    v_pk_mul_f32 v[82:83], v[68:69], v[78:79]
    v_pk_mul_f32 v[84:85], v[70:71], v[78:79]
    v_pk_fma_f32 v[66:67], v[80:81], v[76:77], v[66:67]
    v_pk_fma_f32 v[68:69], v[82:83], v[76:77], v[68:69]
    v_pk_fma_f32 v[70:71], v[84:85], v[76:77], v[70:71]
    v_pk_fma_f32 v[66:67], v[66:67], v[78:79], v[80:81]
    v_pk_fma_f32 v[68:69], v[68:69], v[78:79], v[82:83]
    v_pk_fma_f32 v[70:71], v[70:71], v[78:79], v[84:85]
    v_cvt_pk_bf16_f32 v56, v66, v67
    v_cvt_pk_bf16_f32 v57, v68, v69
    v_cvt_pk_bf16_f32 v58, v70, v71
    v_lshlrev_b32 v66, 16, v56
    v_and_b32 v67, 0xffff0000, v56
    v_lshlrev_b32 v68, 16, v57
    v_and_b32 v69, 0xffff0000, v57
    v_lshlrev_b32 v70, 16, v58
    v_and_b32 v71, 0xffff0000, v58
    v_pk_mul_f32 v[66:67], v[66:67], v[16:17]
    v_pk_mul_f32 v[68:69], v[68:69], v[18:19]
    v_pk_mul_f32 v[70:71], v[70:71], v[20:21]
    v_cvt_pk_bf16_f32 v56, v66, v67
    v_cvt_pk_bf16_f32 v57, v68, v69
    v_cvt_pk_bf16_f32 v58, v70, v71
    v_lshlrev_b32 v66, 16, v56
    v_and_b32 v67, 0xffff0000, v56
    v_lshlrev_b32 v68, 16, v57
    v_and_b32 v69, 0xffff0000, v57
    v_lshlrev_b32 v70, 16, v58
    v_and_b32 v71, 0xffff0000, v58
    v_pk_add_f32 v[66:67], v[66:67], v[22:23]
    v_pk_add_f32 v[68:69], v[68:69], v[24:25]
    v_pk_add_f32 v[70:71], v[70:71], v[26:27]
    v_cvt_pk_bf16_f32 v56, v66, v67
    v_cvt_pk_bf16_f32 v57, v68, v69
    v_cvt_pk_bf16_f32 v58, v70, v71
    s_mov_b32 exec_hi, 0xffff
    ds_write2_b32 v109, v56, v57 offset0:0 offset1:1
    ds_write_b32 v109, v58 offset:8
    s_mov_b64 exec, -1
    s_waitcnt lgkmcnt(0)
    s_barrier
    ds_read_b128 v[56:59], v108 offset:0
    ds_read_b128 v[60:63], v108 offset:64
    ds_read_b128 v[64:67], v108 offset:128
    ds_read_b128 v[68:71], v108 offset:192
    ds_read_b128 v[72:75], v108 offset:256
    ds_read_b128 v[76:79], v108 offset:320
    ds_read_b128 v[80:83], v108 offset:384
    ds_read_b128 v[84:87], v108 offset:448
    ds_read_b128 v[88:91], v108 offset:512
    s_waitcnt lgkmcnt(8)
    v_mfma_f32_16x16x32_bf16 v[236:239], v[56:59], v[128:131], 0
    v_mfma_f32_16x16x32_bf16 v[240:243], v[56:59], v[164:167], 0
    s_waitcnt lgkmcnt(7)
    v_mfma_f32_16x16x32_bf16 v[236:239], v[60:63], v[132:135], v[236:239]
    v_mfma_f32_16x16x32_bf16 v[240:243], v[60:63], v[168:171], v[240:243]
    s_waitcnt lgkmcnt(6)
    v_mfma_f32_16x16x32_bf16 v[236:239], v[64:67], v[136:139], v[236:239]
    v_mfma_f32_16x16x32_bf16 v[240:243], v[64:67], v[172:175], v[240:243]
    s_waitcnt lgkmcnt(5)
    v_mfma_f32_16x16x32_bf16 v[236:239], v[68:71], v[140:143], v[236:239]
    v_mfma_f32_16x16x32_bf16 v[240:243], v[68:71], v[176:179], v[240:243]
    s_waitcnt lgkmcnt(4)
    v_mfma_f32_16x16x32_bf16 v[236:239], v[72:75], v[144:147], v[236:239]
    v_mfma_f32_16x16x32_bf16 v[240:243], v[72:75], v[180:183], v[240:243]
    s_waitcnt lgkmcnt(3)
    v_mfma_f32_16x16x32_bf16 v[236:239], v[76:79], v[148:151], v[236:239]
    v_mfma_f32_16x16x32_bf16 v[240:243], v[76:79], v[184:187], v[240:243]
    s_waitcnt lgkmcnt(2)
    v_mfma_f32_16x16x32_bf16 v[236:239], v[80:83], v[152:155], v[236:239]
    v_mfma_f32_16x16x32_bf16 v[240:243], v[80:83], v[188:191], v[240:243]
    s_waitcnt lgkmcnt(1)
    v_mfma_f32_16x16x32_bf16 v[236:239], v[84:87], v[156:159], v[236:239]
    v_mfma_f32_16x16x32_bf16 v[240:243], v[84:87], v[192:195], v[240:243]
    s_waitcnt lgkmcnt(0)
    v_mfma_f32_16x16x32_bf16 v[236:239], v[88:91], v[160:163], v[236:239]
    v_mfma_f32_16x16x32_bf16 v[240:243], v[88:91], v[196:199], v[240:243]
    s_nop 6
    ds_write2_b32 v92, v236, v237 offset0:0 offset1:16
    ds_write2_b32 v92, v240, v241 offset0:32 offset1:48
    s_waitcnt lgkmcnt(0)
    s_barrier
    ds_read_b32 v57, v93
    ds_read_b32 v59, v93 offset:512
    ds_read_b32 v58, v93 offset:128
    ds_read_b32 v60, v93 offset:640
    s_waitcnt lgkmcnt(2)
    v_add_f32 v57, v57, v59
    s_waitcnt lgkmcnt(0)
    v_add_f32 v58, v58, v60
    v_cvt_pk_bf16_f32 v60, v57, v58
    v_lshlrev_b32 v57, 16, v60
    v_and_b32 v58, 0xffff0000, v60
    v_mul_f32 v60, 0xbfb8aa3b, v57
    v_exp_f32 v60, v60
    s_nop 0
    v_add_f32 v60, 1.0, v60
    v_rcp_f32 v60, v60
    s_nop 0
    v_mul_f32 v57, v57, v60
    v_cvt_pk_bf16_f32 v60, v57, v57
    v_and_b32 v57, 0xffff0000, v60
    v_mul_f32 v57, v57, v58
    v_cvt_pk_bf16_f32 v57, v57, v57
    ds_write_b16 v94, v57
    ds_read_b128 v[80:83], v48
    ds_read_b128 v[84:87], v49
    ds_read_b128 v[88:91], v50
    ds_read_b128 v[92:95], v51
    s_waitcnt lgkmcnt(0)
    v_mfma_f32_16x16x32_bf16 v[96:99], v[80:83], v[200:203], 0
    v_mfma_f32_16x16x32_bf16 v[96:99], v[84:87], v[204:207], v[96:99]
    v_mfma_f32_16x16x32_bf16 v[96:99], v[88:91], v[208:211], v[96:99]
    v_mfma_f32_16x16x32_bf16 v[96:99], v[92:95], v[212:215], v[96:99]
    v_mfma_f32_16x16x32_bf16 v[100:103], v[80:83], v[216:219], 0
    v_mfma_f32_16x16x32_bf16 v[100:103], v[84:87], v[220:223], v[100:103]
    v_mfma_f32_16x16x32_bf16 v[100:103], v[88:91], v[224:227], v[100:103]
    v_mfma_f32_16x16x32_bf16 v[100:103], v[92:95], v[228:231], v[100:103]
    v_mfma_f32_16x16x32_bf16 v[104:107], v[80:83], v[232:235], 0
    s_nop 2
    v_min_u32 v96, v96, v14
    buffer_store_dword v96, v10, s[48:51], s82 offen sc1
    v_min_u32 v97, v97, v14
    buffer_store_dword v97, v10, s[48:51], s83 offen sc1
    v_min_u32 v100, v100, v14
    buffer_store_dword v100, v11, s[48:51], s82 offen sc1
    v_min_u32 v101, v101, v14
    buffer_store_dword v101, v11, s[48:51], s83 offen sc1
    s_mov_b64 exec, 0xffff
    v_min_u32 v104, v104, v14
    buffer_store_dword v104, v12, s[48:51], s82 offen sc1
    v_min_u32 v105, v105, v14
    buffer_store_dword v105, v12, s[48:51], s83 offen sc1
    s_mov_b64 exec, -1
L_t_end:
    s_branch L_end
L_abort:
    s_mov_b32 s52, s40
    s_mov_b32 s53, s41
    s_mov_b32 s54, 256
    s_mov_b32 s55, 0x20000
    v_mov_b32 v2, 252
    v_mov_b32 v3, 0xdead
    s_mov_b64 exec, 1
    buffer_store_dword v3, v2, s[52:55], 0 offen
L_end:
    s_endpgm
.section .rodata,"a"
.p2align 6
.amdhsa_kernel adaLN_cond__gqa_block_cached__swiglu_ffn__decode_kernel
  .amdhsa_next_free_vgpr 256
  .amdhsa_next_free_sgpr 102
  .amdhsa_accum_offset 256
  .amdhsa_group_segment_fixed_size 0
  .amdhsa_kernarg_size 112
  .amdhsa_user_sgpr_count 2
  .amdhsa_user_sgpr_kernarg_segment_ptr 1
  .amdhsa_system_sgpr_workgroup_id_x 1
  .amdhsa_float_denorm_mode_32 3
.end_amdhsa_kernel
```
